```python
import torch

def _softmax(x, axis=-1):
    return torch.softmax(x, dim=axis)
def _gelu(x):
    return torch.nn.functional.gelu(x, approximate="tanh")
def _silu(x):
    return torch.nn.functional.silu(x)
def _sigmoid(x):
    return torch.sigmoid(x)
def _layernorm(x, axis=-1, eps=1e-5):
    m = x.mean(dim=axis, keepdim=True)
    v = x.var(dim=axis, keepdim=True, unbiased=False)
    return (x - m) / torch.sqrt(v + eps)
def _scatter_add(tgt, idx, src, axis=0):
    return tgt.clone().index_add_(axis, idx, src)
def _segment_sum(src, seg, n):
    out = torch.zeros((n,) + src.shape[1:], dtype=src.dtype)
    return out.index_add_(0, seg, src)
def _pad(x, pw):
    flat = tuple(v for pair in reversed(pw) for v in pair)
    return torch.nn.functional.pad(x, flat)

kernel_name = 'sequential_preLN__mha_block_cached__glu_gated_glu__decode'

def setup_inputs():

    _w = (lambda a: (lambda t: t.to(torch.bfloat16) if t.is_floating_point() else t)(torch.as_tensor(a)))
    def _A_setup():
        B, Sq, D = 2, 1, 640
        H, Sk, Dh = 32, 4096, 192
        return {
            "x": _w((lambda *s: torch.randn(*s, dtype=torch.bfloat16) * 0.05)(B, Sq, D)),
            "k_cache": _w((lambda *s: torch.randn(*s, dtype=torch.bfloat16) * 3.2)(B, H, Sk, Dh)),
            "v_cache": _w((lambda *s: torch.randn(*s, dtype=torch.bfloat16) * 0.4)(B, H, Sk, Dh)),
            "wq": _w((lambda *s: torch.randn(*s, dtype=torch.bfloat16) * 3.2)(D, H * Dh) * (D ** -0.5)),
            "wo": _w((lambda *s: torch.randn(*s, dtype=torch.bfloat16) * 0.4)(H * Dh, D) * ((H * Dh) ** -0.5)),
        }
    _A_in = _A_setup()

    def _B_setup():
        B, S, D, F = 2, 1, 640, 1536
        return {
            "x": _w((lambda *s: torch.randn(*s, dtype=torch.bfloat16) * 0.05)(B, S, D)),
            "w_gate": _w((lambda *s: torch.randn(*s, dtype=torch.bfloat16) * 0.1)(D, F)),
            "w_up": _w((lambda *s: torch.randn(*s, dtype=torch.bfloat16) * 0.05)(D, F)),
            "w_down": _w((lambda *s: torch.randn(*s, dtype=torch.bfloat16) * 0.05)(F, D)),
        }
    _B_in = _B_setup()

    return {
        "A_x": _A_in["x"],
        "A_k_cache": _A_in["k_cache"],
        "A_v_cache": _A_in["v_cache"],
        "A_wq": _A_in["wq"],
        "A_wo": _A_in["wo"],
        "B_x": _B_in["x"],
        "B_w_gate": _B_in["w_gate"],
        "B_w_up": _B_in["w_up"],
        "B_w_down": _B_in["w_down"],
    }

def reference(A_x, A_k_cache, A_v_cache, A_wq, A_wo, B_x, B_w_gate, B_w_up, B_w_down):
    def _A_ref(x, k_cache, v_cache, wq, wo):
        B, Sq, D = x.shape
        H, Dh = 32, 192
        q = (lambda x, *d: x.permute(*d))((x @ wq).reshape(B, Sq, H, Dh), 0, 2, 1, 3)
        scores = torch.einsum("bhqd,bhkd->bhqk", q, k_cache) * (Dh ** -0.5)
        p = _softmax(scores, axis=-1)
        o = torch.einsum("bhqk,bhkd->bhqd", p, v_cache)
        return (lambda x, *d: x.permute(*d))(o, 0, 2, 1, 3).reshape(B, Sq, H * Dh) @ wo

    def _B_ref(x, w_gate, w_up, w_down):
        g = torch.einsum("bsd,df->bsf", x, w_gate)
        u = torch.einsum("bsd,df->bsf", x, w_up)
        h = _sigmoid(g) * u
        return torch.einsum("bsf,fd->bsd", h, w_down)

    x = A_x
    h = x + _A_ref(_layernorm(x, axis=-1), A_k_cache, A_v_cache, A_wq, A_wo)
    h2 = h + _B_ref(_layernorm(h, axis=-1), B_w_gate, B_w_up, B_w_down)
    return h2
```

```asm
; @launch grid=(256,1,1) block=(512,1,1) lds=163840
.amdgcn_target "amdgcn-amd-amdhsa--gfx950"
.text
.globl sequential_preLN__mha_block_cached__glu_gated_glu__decode_kernel
.p2align 8
.type sequential_preLN__mha_block_cached__glu_gated_glu__decode_kernel,@function
sequential_preLN__mha_block_cached__glu_gated_glu__decode_kernel:
  s_cmp_ge_u32 s2, 256
  s_cbranch_scc1 L_end
  s_load_dwordx16 s[4:19], s[0:1], 0
  s_load_dwordx4 s[20:23], s[0:1], 64
  s_load_dwordx2 s[26:27], s[0:1], 88
  v_lshrrev_b32 v1, 6, v0
  v_and_b32 v0, 63, v0
  v_readfirstlane_b32 s48, v1
  s_lshr_b32 s49, s2, 3
  s_and_b32 s50, s2, 7
  s_lshr_b32 s52, s50, 1
  s_xor_b32 s51, s50, s52
  s_and_b32 s51, s51, 1
  v_and_b32 v43, 7, v0
  v_bfe_u32 v44, v0, 3, 1
  v_lshrrev_b32 v45, 4, v0
  v_lshrrev_b32 v1, 3, v0
  v_mul_u32_u24 v1, 384, v1
  v_lshl_add_u32 v1, v43, 4, v1
  s_lshl_b32 s3, s51, 5
  s_add_u32 s3, s3, s49
  s_mul_i32 s65, s3, 1572864
  s_mul_i32 s24, s3, 104
  s_lshr_b32 s66, s49, 2
  s_mul_i32 s66, s66, 0
  s_add_u32 s24, s24, s66
  s_mul_i32 s66, s51, 32
  s_add_u32 s24, s24, s66
  s_lshl_b32 s3, s3, 8
  s_add_u32 s53, s3, 102400
  s_add_u32 s69, s52, s49
  s_and_b32 s69, s69, 3
  s_lshr_b32 s66, s49, 2
  s_lshl_b32 s67, s69, 3
  s_add_u32 s67, s67, s66
  s_lshl_b32 s54, s67, 3
  s_add_u32 s54, s54, s50
  s_mul_i32 s68, s50, 6
  s_add_u32 s68, s68, s66
  s_add_u32 s68, s68, 78
  s_sub_u32 s67, s67, 10
  s_cmp_lt_u32 s67, 6
  s_cselect_b32 s54, s68, s54
  s_and_b32 s50, s50, 1
  s_mul_i32 s66, s69, 96
  s_mul_i32 s67, s69, 96
  s_sub_u32 s67, s67, 0
  s_cmp_lt_u32 s69, 2
  s_cselect_b32 s62, s66, s67
  s_mov_b32 s66, 96
  s_cselect_b32 s64, 96, s66
  s_add_u32 s64, s64, s62
  s_mov_b32 s63, 0x3fb8aa3b
  v_mov_b32 v41, 134528
  s_cmp_eq_u32 s48, 7
  s_cbranch_scc1 L_nload
  s_cmp_eq_u32 s69, 1
  s_cbranch_scc1 L_pstart_r
  s_cmp_lt_u32 s48, 4
  s_cbranch_scc1 L_qstart
  s_cmp_eq_u32 s69, 0
  s_cbranch_scc1 L_pstart_r
  s_branch L_pstart_n
L_qstart:
  v_lshl_add_u32 v46, v45, 3, v43
  v_mul_u32_u24 v46, 40, v46
  v_mul_u32_u24 v47, 1280, v44
  v_add_u32 v46, v46, v47
  v_mad_u32_u24 v47, v45, 40, v47
  v_mad_u32_u24 v9, v45, 20, v44
  v_mul_u32_u24 v9, 12288, v9
  v_lshl_add_u32 v9, v43, 4, v9
  s_lshl_b32 s67, s50, 2
  s_add_u32 s67, s67, s48
  s_mul_i32 s3, s67, 983040
  s_mul_i32 s66, s49, 384
  s_add_u32 s3, s3, s66
  s_min_u32 s66, s69, 1
  s_sub_u32 s61, s69, s66
  s_lshl_b32 s66, s61, 7
  s_add_u32 s3, s3, s66
  s_mul_i32 s66, s67, 160
  s_waitcnt lgkmcnt(0)
  s_load_dword s55, s[26:27], 0
  s_mov_b32 s40, s4
  s_mov_b32 s41, s5
  s_mov_b32 s42, 2560
  s_mov_b32 s43, 0x20000
  buffer_load_dwordx4 v[160:163], v46, s[40:43], 0 offen
  buffer_load_dwordx4 v[164:167], v46, s[40:43], 0 offen offset:16
  buffer_load_dwordx2 v[168:169], v46, s[40:43], 0 offen offset:32
  buffer_load_dwordx2 v[170:171], v47, s[40:43], s66 offen
  buffer_load_dwordx4 v[172:175], v47, s[40:43], s66 offen offset:8
  buffer_load_dwordx4 v[176:179], v47, s[40:43], s66 offen offset:24
  s_add_u32 s44, s10, s3
  s_addc_u32 s45, s11, 0
  s_mov_b32 s46, 970880
  s_mov_b32 s47, 0x20000
  buffer_load_dwordx4 v[120:123], v9, s[44:47], 0 offen nt
  s_mov_b32 s66, 24576
  buffer_load_dwordx4 v[124:127], v9, s[44:47], s66 offen nt
  s_mov_b32 s66, 49152
  buffer_load_dwordx4 v[128:131], v9, s[44:47], s66 offen nt
  s_mov_b32 s66, 73728
  buffer_load_dwordx4 v[132:135], v9, s[44:47], s66 offen nt
  s_mov_b32 s66, 98304
  buffer_load_dwordx4 v[136:139], v9, s[44:47], s66 offen nt
  s_mov_b32 s66, 122880
  buffer_load_dwordx4 v[140:143], v9, s[44:47], s66 offen nt
  s_mov_b32 s66, 147456
  buffer_load_dwordx4 v[144:147], v9, s[44:47], s66 offen nt
  s_mov_b32 s66, 172032
  buffer_load_dwordx4 v[148:151], v9, s[44:47], s66 offen nt
  s_mov_b32 s66, 196608
  buffer_load_dwordx4 v[152:155], v9, s[44:47], s66 offen nt
  s_mov_b32 s66, 221184
  buffer_load_dwordx4 v[156:159], v9, s[44:47], s66 offen nt
  s_barrier
  s_add_u32 s28, s6, s65
  s_addc_u32 s29, s7, 0
  s_mov_b32 s30, 1572864
  s_mov_b32 s31, 0x20000
  s_add_u32 s32, s8, s65
  s_addc_u32 s33, s9, 0
  s_mov_b32 s34, 1572864
  s_mov_b32 s35, 0x20000
  s_mov_b32 s36, s26
  s_mov_b32 s37, s27
  s_mov_b32 s38, 1507328
  s_mov_b32 s39, 0x20000
  s_xor_b32 s3, s48, 3
  s_or_b32 s3, s3, s69
  s_cmp_lg_u32 s3, 0
  s_cselect_b32 s3, 1507328, s53
  v_mov_b32 v12, 424
  v_mov_b32 v13, 384
  s_mov_b64 exec, 1
  buffer_store_dwordx2 v[12:13], off, s[36:39], s3 sc1
  s_mov_b64 exec, -1
  v_and_b32 v10, 1, v0
  v_lshlrev_b32 v10, 4, v10
  v_mov_b32 v11, 0xffff
  v_lshlrev_b32 v10, v10, v11
  v_lshrrev_b32 v11, 1, v43
  v_cmp_eq_u32 vcc, 0, v11
  v_cmp_eq_u32 s[66:67], 1, v11
  v_mov_b32 v6, 0xff800000
  v_mov_b32 v7, 0x7f800000
  v_cndmask_b32 v2, 0, v10, vcc
  v_cndmask_b32 v3, 0, v10, s[66:67]
  v_cmp_eq_u32 vcc, 2, v11
  v_cmp_eq_u32 s[66:67], 3, v11
  v_mov_b32 v8, 0
  v_mov_b32 v46, 1
  v_cndmask_b32 v4, 0, v10, vcc
  v_cndmask_b32 v5, 0, v10, s[66:67]
  s_lshl_b32 s3, s48, 9
  s_add_u32 s3, s3, 141824
  v_lshl_add_u32 v47, v0, 3, s3
  s_mov_b32 s68, 0x3f803f80
  s_mov_b32 s67, 0x00003f80
  s_waitcnt vmcnt(14)
  v_dot2_f32_bf16 v10, v160, s68, 0
  v_dot2_f32_bf16 v11, v160, v160, 0
  v_dot2_f32_bf16 v10, v161, s68, v10
  v_dot2_f32_bf16 v11, v161, v161, v11
  v_dot2_f32_bf16 v10, v162, s68, v10
  v_dot2_f32_bf16 v11, v162, v162, v11
  v_dot2_f32_bf16 v10, v163, s68, v10
  v_dot2_f32_bf16 v11, v163, v163, v11
  v_dot2_f32_bf16 v10, v164, s68, v10
  v_dot2_f32_bf16 v11, v164, v164, v11
  v_dot2_f32_bf16 v10, v165, s68, v10
  v_dot2_f32_bf16 v11, v165, v165, v11
  v_dot2_f32_bf16 v10, v166, s68, v10
  v_dot2_f32_bf16 v11, v166, v166, v11
  v_dot2_f32_bf16 v10, v167, s68, v10
  v_dot2_f32_bf16 v11, v167, v167, v11
  v_dot2_f32_bf16 v10, v168, s68, v10
  v_dot2_f32_bf16 v11, v168, v168, v11
  v_dot2_f32_bf16 v10, v169, s68, v10
  v_dot2_f32_bf16 v11, v169, v169, v11
  s_nop 1
  v_add_f32_dpp v10, v10, v10 quad_perm:[1,0,3,2] row_mask:0xf bank_mask:0xf
  v_add_f32_dpp v11, v11, v11 quad_perm:[1,0,3,2] row_mask:0xf bank_mask:0xf
  s_nop 0
  v_add_f32_dpp v10, v10, v10 quad_perm:[2,3,0,1] row_mask:0xf bank_mask:0xf
  v_add_f32_dpp v11, v11, v11 quad_perm:[2,3,0,1] row_mask:0xf bank_mask:0xf
  s_nop 0
  v_add_f32_dpp v10, v10, v10 row_half_mirror row_mask:0xf bank_mask:0xf
  v_add_f32_dpp v11, v11, v11 row_half_mirror row_mask:0xf bank_mask:0xf
  v_mov_b32 v12, v10
  v_mov_b32 v13, v11
  s_nop 0
  v_permlane16_swap_b32 v10, v12
  v_permlane16_swap_b32 v11, v13
  v_add_f32 v10, v10, v12
  v_add_f32 v11, v11, v13
  v_mov_b32 v12, v10
  v_mov_b32 v13, v11
  s_nop 0
  v_permlane32_swap_b32 v10, v12
  v_permlane32_swap_b32 v11, v13
  v_add_f32 v10, v10, v12
  v_add_f32 v11, v11, v13
  v_mul_f32 v10, 0x3acccccd, v10
  v_mul_f32 v11, 0x3acccccd, v11
  v_fma_f32 v11, -v10, v10, v11
  v_max_f32 v11, 0, v11
  v_cvt_pk_bf16_f32 v12, -v10, v11
  v_lshlrev_b32 v10, 16, v12
  v_and_b32 v11, 0xffff0000, v12
  v_add_f32 v11, 0x3727c5ac, v11
  v_cvt_pk_bf16_f32 v11, v11, v11
  v_lshlrev_b32 v11, 16, v11
  v_sqrt_f32 v11, v11
  s_nop 0
  v_cvt_pk_bf16_f32 v11, v11, v11
  v_lshlrev_b32 v11, 16, v11
  v_rcp_f32 v11, v11
  s_mov_b32 s68, 0x3f800000
  s_waitcnt vmcnt(11)
  v_dot2_f32_bf16 v180, v170, s67, v10
  v_dot2_f32_bf16 v181, v170, s68, v10
  v_dot2_f32_bf16 v182, v171, s67, v10
  v_dot2_f32_bf16 v183, v171, s68, v10
  v_dot2_f32_bf16 v184, v172, s67, v10
  v_dot2_f32_bf16 v185, v172, s68, v10
  v_dot2_f32_bf16 v186, v173, s67, v10
  v_dot2_f32_bf16 v187, v173, s68, v10
  v_dot2_f32_bf16 v188, v174, s67, v10
  v_dot2_f32_bf16 v189, v174, s68, v10
  v_dot2_f32_bf16 v190, v175, s67, v10
  v_dot2_f32_bf16 v191, v175, s68, v10
  v_dot2_f32_bf16 v192, v176, s67, v10
  v_dot2_f32_bf16 v193, v176, s68, v10
  v_dot2_f32_bf16 v194, v177, s67, v10
  v_dot2_f32_bf16 v195, v177, s68, v10
  v_dot2_f32_bf16 v196, v178, s67, v10
  v_dot2_f32_bf16 v197, v178, s68, v10
  v_dot2_f32_bf16 v198, v179, s67, v10
  v_dot2_f32_bf16 v199, v179, s68, v10
  v_cvt_pk_bf16_f32 v170, v180, v181
  v_cvt_pk_bf16_f32 v171, v182, v183
  v_cvt_pk_bf16_f32 v172, v184, v185
  v_cvt_pk_bf16_f32 v173, v186, v187
  v_cvt_pk_bf16_f32 v174, v188, v189
  v_cvt_pk_bf16_f32 v175, v190, v191
  v_cvt_pk_bf16_f32 v176, v192, v193
  v_cvt_pk_bf16_f32 v177, v194, v195
  v_cvt_pk_bf16_f32 v178, v196, v197
  v_cvt_pk_bf16_f32 v179, v198, v199
  v_lshlrev_b32 v180, 16, v170
  v_and_b32 v181, 0xffff0000, v170
  v_mul_f32 v180, v180, v11
  v_mul_f32 v181, v181, v11
  v_cvt_pk_bf16_f32 v180, v180, v180
  v_cvt_pk_bf16_f32 v181, v181, v181
  v_and_b32 v200, v2, v180
  v_and_b32 v201, v3, v180
  v_and_b32 v202, v4, v180
  v_and_b32 v203, v5, v180
  v_and_b32 v204, v2, v181
  v_and_b32 v205, v3, v181
  v_and_b32 v206, v4, v181
  v_and_b32 v207, v5, v181
  s_waitcnt vmcnt(10)
  v_mfma_f32_16x16x32_bf16 v[16:19], v[120:123], v[200:203], 0
  v_mfma_f32_16x16x32_bf16 v[20:23], v[120:123], v[204:207], 0
  v_lshlrev_b32 v182, 16, v171
  v_and_b32 v183, 0xffff0000, v171
  v_mul_f32 v182, v182, v11
  v_mul_f32 v183, v183, v11
  v_cvt_pk_bf16_f32 v182, v182, v182
  v_cvt_pk_bf16_f32 v183, v183, v183
  v_and_b32 v208, v2, v182
  v_and_b32 v209, v3, v182
  v_and_b32 v210, v4, v182
  v_and_b32 v211, v5, v182
  v_and_b32 v212, v2, v183
  v_and_b32 v213, v3, v183
  v_and_b32 v214, v4, v183
  v_and_b32 v215, v5, v183
  s_waitcnt vmcnt(9)
  v_mfma_f32_16x16x32_bf16 v[16:19], v[124:127], v[208:211], v[16:19]
  v_mfma_f32_16x16x32_bf16 v[20:23], v[124:127], v[212:215], v[20:23]
  v_lshlrev_b32 v184, 16, v172
  v_and_b32 v185, 0xffff0000, v172
  v_mul_f32 v184, v184, v11
  v_mul_f32 v185, v185, v11
  v_cvt_pk_bf16_f32 v184, v184, v184
  v_cvt_pk_bf16_f32 v185, v185, v185
  v_and_b32 v200, v2, v184
  v_and_b32 v201, v3, v184
  v_and_b32 v202, v4, v184
  v_and_b32 v203, v5, v184
  v_and_b32 v204, v2, v185
  v_and_b32 v205, v3, v185
  v_and_b32 v206, v4, v185
  v_and_b32 v207, v5, v185
  s_waitcnt vmcnt(8)
  v_mfma_f32_16x16x32_bf16 v[16:19], v[128:131], v[200:203], v[16:19]
  v_mfma_f32_16x16x32_bf16 v[20:23], v[128:131], v[204:207], v[20:23]
  v_lshlrev_b32 v186, 16, v173
  v_and_b32 v187, 0xffff0000, v173
  v_mul_f32 v186, v186, v11
  v_mul_f32 v187, v187, v11
  v_cvt_pk_bf16_f32 v186, v186, v186
  v_cvt_pk_bf16_f32 v187, v187, v187
  v_and_b32 v208, v2, v186
  v_and_b32 v209, v3, v186
  v_and_b32 v210, v4, v186
  v_and_b32 v211, v5, v186
  v_and_b32 v212, v2, v187
  v_and_b32 v213, v3, v187
  v_and_b32 v214, v4, v187
  v_and_b32 v215, v5, v187
  s_waitcnt vmcnt(7)
  v_mfma_f32_16x16x32_bf16 v[16:19], v[132:135], v[208:211], v[16:19]
  v_mfma_f32_16x16x32_bf16 v[20:23], v[132:135], v[212:215], v[20:23]
  v_lshlrev_b32 v188, 16, v174
  v_and_b32 v189, 0xffff0000, v174
  v_mul_f32 v188, v188, v11
  v_mul_f32 v189, v189, v11
  v_cvt_pk_bf16_f32 v188, v188, v188
  v_cvt_pk_bf16_f32 v189, v189, v189
  v_and_b32 v200, v2, v188
  v_and_b32 v201, v3, v188
  v_and_b32 v202, v4, v188
  v_and_b32 v203, v5, v188
  v_and_b32 v204, v2, v189
  v_and_b32 v205, v3, v189
  v_and_b32 v206, v4, v189
  v_and_b32 v207, v5, v189
  s_waitcnt vmcnt(6)
  v_mfma_f32_16x16x32_bf16 v[16:19], v[136:139], v[200:203], v[16:19]
  v_mfma_f32_16x16x32_bf16 v[20:23], v[136:139], v[204:207], v[20:23]
  v_lshlrev_b32 v190, 16, v175
  v_and_b32 v191, 0xffff0000, v175
  v_mul_f32 v190, v190, v11
  v_mul_f32 v191, v191, v11
  v_cvt_pk_bf16_f32 v190, v190, v190
  v_cvt_pk_bf16_f32 v191, v191, v191
  v_and_b32 v208, v2, v190
  v_and_b32 v209, v3, v190
  v_and_b32 v210, v4, v190
  v_and_b32 v211, v5, v190
  v_and_b32 v212, v2, v191
  v_and_b32 v213, v3, v191
  v_and_b32 v214, v4, v191
  v_and_b32 v215, v5, v191
  s_waitcnt vmcnt(5)
  v_mfma_f32_16x16x32_bf16 v[16:19], v[140:143], v[208:211], v[16:19]
  v_mfma_f32_16x16x32_bf16 v[20:23], v[140:143], v[212:215], v[20:23]
  v_lshlrev_b32 v192, 16, v176
  v_and_b32 v193, 0xffff0000, v176
  v_mul_f32 v192, v192, v11
  v_mul_f32 v193, v193, v11
  v_cvt_pk_bf16_f32 v192, v192, v192
  v_cvt_pk_bf16_f32 v193, v193, v193
  v_and_b32 v200, v2, v192
  v_and_b32 v201, v3, v192
  v_and_b32 v202, v4, v192
  v_and_b32 v203, v5, v192
  v_and_b32 v204, v2, v193
  v_and_b32 v205, v3, v193
  v_and_b32 v206, v4, v193
  v_and_b32 v207, v5, v193
  s_waitcnt vmcnt(4)
  v_mfma_f32_16x16x32_bf16 v[16:19], v[144:147], v[200:203], v[16:19]
  v_mfma_f32_16x16x32_bf16 v[20:23], v[144:147], v[204:207], v[20:23]
  v_lshlrev_b32 v194, 16, v177
  v_and_b32 v195, 0xffff0000, v177
  v_mul_f32 v194, v194, v11
  v_mul_f32 v195, v195, v11
  v_cvt_pk_bf16_f32 v194, v194, v194
  v_cvt_pk_bf16_f32 v195, v195, v195
  v_and_b32 v208, v2, v194
  v_and_b32 v209, v3, v194
  v_and_b32 v210, v4, v194
  v_and_b32 v211, v5, v194
  v_and_b32 v212, v2, v195
  v_and_b32 v213, v3, v195
  v_and_b32 v214, v4, v195
  v_and_b32 v215, v5, v195
  s_waitcnt vmcnt(3)
  v_mfma_f32_16x16x32_bf16 v[16:19], v[148:151], v[208:211], v[16:19]
  v_mfma_f32_16x16x32_bf16 v[20:23], v[148:151], v[212:215], v[20:23]
  v_lshlrev_b32 v196, 16, v178
  v_and_b32 v197, 0xffff0000, v178
  v_mul_f32 v196, v196, v11
  v_mul_f32 v197, v197, v11
  v_cvt_pk_bf16_f32 v196, v196, v196
  v_cvt_pk_bf16_f32 v197, v197, v197
  v_and_b32 v200, v2, v196
  v_and_b32 v201, v3, v196
  v_and_b32 v202, v4, v196
  v_and_b32 v203, v5, v196
  v_and_b32 v204, v2, v197
  v_and_b32 v205, v3, v197
  v_and_b32 v206, v4, v197
  v_and_b32 v207, v5, v197
  s_waitcnt vmcnt(2)
  v_mfma_f32_16x16x32_bf16 v[16:19], v[152:155], v[200:203], v[16:19]
  v_mfma_f32_16x16x32_bf16 v[20:23], v[152:155], v[204:207], v[20:23]
  v_lshlrev_b32 v198, 16, v179
  v_and_b32 v199, 0xffff0000, v179
  v_mul_f32 v198, v198, v11
  v_mul_f32 v199, v199, v11
  v_cvt_pk_bf16_f32 v198, v198, v198
  v_cvt_pk_bf16_f32 v199, v199, v199
  v_and_b32 v208, v2, v198
  v_and_b32 v209, v3, v198
  v_and_b32 v210, v4, v198
  v_and_b32 v211, v5, v198
  v_and_b32 v212, v2, v199
  v_and_b32 v213, v3, v199
  v_and_b32 v214, v4, v199
  v_and_b32 v215, v5, v199
  s_waitcnt vmcnt(1)
  v_mfma_f32_16x16x32_bf16 v[16:19], v[156:159], v[208:211], v[16:19]
  v_mfma_f32_16x16x32_bf16 v[20:23], v[156:159], v[212:215], v[20:23]
  s_nop 6
  v_permlane32_swap_b32 v16, v18
  v_permlane32_swap_b32 v17, v19
  v_permlane32_swap_b32 v20, v22
  v_permlane32_swap_b32 v21, v23
  v_add_f32 v12, v16, v22
  v_add_f32 v13, v17, v23
  ds_write_b64 v47, v[12:13]
  s_mov_b64 exec, 1
  ds_add_u32 v41, v46 offset:8
  s_mov_b64 exec, -1
  s_cmp_eq_u32 s48, 3
  s_cbranch_scc0 L_qtop
  v_lshlrev_b32 v9, 4, v0
  v_add_u32 v12, 141824, v9
  v_bfe_u32 v13, v0, 2, 1
  v_mul_u32_u24 v13, 1536, v13
  v_lshrrev_b32 v14, 3, v0
  v_lshl_add_u32 v13, v14, 6, v13
  v_and_b32 v14, 3, v0
  v_lshl_add_u32 v13, v14, 4, v13
  v_mov_b32 v47, 0xffffff00
  s_mul_i32 s3, s50, 3
  s_add_u32 s3, s3, s61
  s_lshl_b32 s3, s3, 8
  s_mul_i32 s66, s49, 3072
  s_add_u32 s66, s66, s3
  s_add_u32 s66, s66, 4096
L_qcw:
  ds_read_b32 v10, v41 offset:8
  s_waitcnt lgkmcnt(0)
  v_cmp_ne_u32 vcc, 4, v10
  s_cbranch_vccnz L_qcw
  ds_read_b128 v[16:19], v12
  ds_read_b128 v[20:23], v12 offset:1024
  s_mul_i32 s3, s55, 1664525
  s_add_u32 s3, s3, 1013904223
  s_or_b32 s3, s3, 0x01010101
  s_xor_b32 s55, s55, s3
  s_and_b32 s56, s55, 0xff
  s_bfe_u32 s57, s55, 0x80008
  s_bfe_u32 s58, s55, 0x80010
  s_lshr_b32 s59, s55, 24
  s_waitcnt lgkmcnt(0)
  v_pk_add_f32 v[16:17], v[16:17], v[20:21]
  v_pk_add_f32 v[18:19], v[18:19], v[22:23]
  v_mov_b32 v20, v16
  v_mov_b32 v21, v17
  v_mov_b32 v22, v18
  v_mov_b32 v23, v19
  v_permlane32_swap_b32 v16, v20
  v_permlane32_swap_b32 v17, v21
  v_permlane32_swap_b32 v18, v22
  v_permlane32_swap_b32 v19, v23
  v_pk_add_f32 v[16:17], v[16:17], v[20:21]
  v_pk_add_f32 v[18:19], v[18:19], v[22:23]
  v_and_or_b32 v16, v16, v47, s56
  v_and_or_b32 v17, v17, v47, s57
  v_and_or_b32 v18, v18, v47, s58
  v_and_or_b32 v19, v19, v47, s59
  s_waitcnt vmcnt(0)
  s_mov_b32 exec_hi, 0
  buffer_store_dwordx4 v[16:19], v13, s[36:39], s66 offen sc1
  s_mov_b32 exec_hi, -1
L_qgather:
  s_lshl_b32 s3, s49, 1
  s_add_u32 s3, s3, s51
  s_mul_i32 s3, s3, 1536
  s_add_u32 s68, s3, 4096
  v_lshlrev_b32 v9, 4, v0
  v_bfe_u32 v12, v0, 2, 1
  v_lshl_add_u32 v12, v45, 1, v12
  v_lshl_add_u32 v12, v12, 1, v44
  v_and_b32 v13, 3, v0
  v_lshl_add_u32 v12, v12, 3, v13
  v_lshlrev_b32 v12, 2, v12
  v_add_u32 v12, 134144, v12
  s_mov_b32 s61, 0
  s_mov_b32 exec_hi, 0xffff
L_qpoll:
  buffer_load_dwordx4 v[16:19], v9, s[36:39], s68 offen sc1
  buffer_load_dwordx4 v[20:23], v9, s[36:39], s68 offen offset:768 sc1
  s_add_u32 s61, s61, 1
  s_cmp_ge_u32 s61, 200000
  s_waitcnt vmcnt(0)
  s_cbranch_scc1 L_qdone
  v_xor_b32 v16, s56, v16
  v_xor_b32 v17, s57, v17
  v_xor_b32 v18, s58, v18
  v_xor_b32 v19, s59, v19
  v_xor_b32 v20, s56, v20
  v_xor_b32 v21, s57, v21
  v_xor_b32 v22, s58, v22
  v_xor_b32 v23, s59, v23
  v_or3_b32 v10, v16, v17, v18
  v_or3_b32 v11, v19, v20, v21
  v_or3_b32 v10, v10, v22, v23
  v_or_b32 v10, v10, v11
  v_and_b32 v10, 0xff, v10
  v_cmp_ne_u32 vcc, 0, v10
  s_cbranch_vccnz L_qpoll
L_qdone:
  v_pk_add_f32 v[16:17], v[16:17], v[20:21]
  v_pk_add_f32 v[18:19], v[18:19], v[22:23]
  v_cvt_pk_bf16_f32 v10, v16, v18
  v_cvt_pk_bf16_f32 v11, v17, v19
  ds_write2_b32 v12, v10, v11 offset1:4
  s_mov_b64 exec, 1
  ds_add_u32 v41, v46 offset:4
  s_mov_b64 exec, -1
L_qtop:
  v_mov_b32 v16, 0
  v_mov_b32 v17, 0
  v_mov_b32 v18, 0
  v_mov_b32 v19, 0
  v_mov_b32 v20, 0
  v_mov_b32 v21, 0
  v_mov_b32 v22, 0
  v_mov_b32 v23, 0
  v_mov_b32 v24, 0
  v_mov_b32 v25, 0
  v_mov_b32 v26, 0
  v_mov_b32 v27, 0
  s_cmp_lt_u32 s54, 128
  s_cbranch_scc1 L_pfr
  s_branch L_pfn
L_pstart_r:
  v_and_b32 v10, 1, v0
  v_lshlrev_b32 v10, 4, v10
  v_mov_b32 v11, 0xffff
  v_lshlrev_b32 v10, v10, v11
  v_lshrrev_b32 v11, 1, v43
  v_cmp_eq_u32 vcc, 0, v11
  v_cmp_eq_u32 s[66:67], 1, v11
  v_mov_b32 v6, 0xff800000
  v_mov_b32 v7, 0x7f800000
  v_cndmask_b32 v2, 0, v10, vcc
  v_cndmask_b32 v3, 0, v10, s[66:67]
  v_cmp_eq_u32 vcc, 2, v11
  v_cmp_eq_u32 s[66:67], 3, v11
  v_mov_b32 v8, 0
  v_mov_b32 v46, 1
  v_cndmask_b32 v4, 0, v10, vcc
  v_cndmask_b32 v5, 0, v10, s[66:67]
  v_mov_b32 v16, 0
  v_mov_b32 v17, 0
  v_mov_b32 v18, 0
  v_mov_b32 v19, 0
  v_mov_b32 v20, 0
  v_mov_b32 v21, 0
  v_mov_b32 v22, 0
  v_mov_b32 v23, 0
  v_mov_b32 v24, 0
  v_mov_b32 v25, 0
  v_mov_b32 v26, 0
  v_mov_b32 v27, 0
  s_waitcnt lgkmcnt(0)
  s_load_dword s55, s[26:27], 0
  s_add_u32 s28, s6, s65
  s_addc_u32 s29, s7, 0
  s_mov_b32 s30, 1572864
  s_mov_b32 s31, 0x20000
  s_add_u32 s32, s8, s65
  s_addc_u32 s33, s9, 0
  s_mov_b32 s34, 1572864
  s_mov_b32 s35, 0x20000
  s_mov_b32 s36, s26
  s_mov_b32 s37, s27
  s_mov_b32 s38, 1507328
  s_mov_b32 s39, 0x20000
  s_barrier
  s_cmp_eq_u32 s48, 3
  s_cbranch_scc0 L_pfr
  s_waitcnt lgkmcnt(0)
  s_mul_i32 s3, s55, 1664525
  s_add_u32 s3, s3, 1013904223
  s_or_b32 s3, s3, 0x01010101
  s_xor_b32 s55, s55, s3
  s_and_b32 s56, s55, 0xff
  s_bfe_u32 s57, s55, 0x80008
  s_bfe_u32 s58, s55, 0x80010
  s_lshr_b32 s59, s55, 24
  s_branch L_qgather
L_pfr:
  s_mov_b32 s60, s48
  s_add_u32 s66, s60, 7
  s_mul_i32 s45, s69, 0
  s_add_u32 s45, s45, 384
  s_sub_u32 s46, s62, 0
  v_lshrrev_b32 v40, 3, v0
  v_lshlrev_b32 v40, 2, v40
  v_add_u32 v40, 143872, v40
  s_mov_b32 s6, s62
  s_mov_b32 s7, 1366
  s_mov_b32 s8, 9
  s_mul_i32 s9, s62, 128
  s_lshr_b32 s9, s9, 12
  s_sub_u32 s9, s9, s62
  s_add_u32 s15, s46, s60
  s_sub_u32 s25, s15, s6
  s_mul_i32 s25, s25, s7
  s_lshr_b32 s25, s25, 12
  s_mul_i32 s25, s25, s8
  s_add_u32 s25, s25, s9
  s_cmp_lt_u32 s15, 384
  s_cselect_b32 s25, s25, 0
  s_add_u32 s25, s25, s15
  s_add_u32 s25, s25, s24
  s_and_b32 s25, s25, 511
  s_mul_i32 s25, s25, 3072
  buffer_load_dwordx4 v[48:51], v1, s[28:31], s25 offen offset:0 nt
  buffer_load_dwordx4 v[52:55], v1, s[28:31], s25 offen offset:128 nt
  buffer_load_dwordx4 v[56:59], v1, s[28:31], s25 offen offset:256 nt
  v_lshl_add_u32 v216, s15, 5, v40
  s_mov_b32 s60, s66
  s_add_u32 s66, s66, 7
  s_add_u32 s15, s46, s60
  s_sub_u32 s25, s15, s6
  s_mul_i32 s25, s25, s7
  s_lshr_b32 s25, s25, 12
  s_mul_i32 s25, s25, s8
  s_add_u32 s25, s25, s9
  s_cmp_lt_u32 s15, 384
  s_cselect_b32 s25, s25, 0
  s_add_u32 s25, s25, s15
  s_add_u32 s25, s25, s24
  s_and_b32 s25, s25, 511
  s_mul_i32 s25, s25, 3072
  buffer_load_dwordx4 v[60:63], v1, s[28:31], s25 offen offset:0 nt
  buffer_load_dwordx4 v[64:67], v1, s[28:31], s25 offen offset:128 nt
  s_waitcnt vmcnt(4)
  buffer_load_dwordx4 v[68:71], v1, s[28:31], s25 offen offset:256 nt
  v_lshl_add_u32 v217, s15, 5, v40
  s_mov_b32 s60, s66
  s_add_u32 s66, s66, 7
  s_add_u32 s15, s46, s60
  s_sub_u32 s25, s15, s6
  s_mul_i32 s25, s25, s7
  s_lshr_b32 s25, s25, 12
  s_mul_i32 s25, s25, s8
  s_add_u32 s25, s25, s9
  s_cmp_lt_u32 s15, 384
  s_cselect_b32 s25, s25, 0
  s_add_u32 s25, s25, s15
  s_add_u32 s25, s25, s24
  s_and_b32 s25, s25, 511
  s_mul_i32 s25, s25, 3072
  s_waitcnt vmcnt(4)
  buffer_load_dwordx4 v[72:75], v1, s[28:31], s25 offen offset:0 nt
  s_waitcnt vmcnt(4)
  buffer_load_dwordx4 v[76:79], v1, s[28:31], s25 offen offset:128 nt
  s_waitcnt vmcnt(4)
  buffer_load_dwordx4 v[80:83], v1, s[28:31], s25 offen offset:256 nt
  v_lshl_add_u32 v218, s15, 5, v40
  s_mov_b32 s60, s66
  s_mov_b64 exec, 1
  ds_add_rtn_u32 v42, v41, v46 offset:20
  s_mov_b64 exec, -1
  ds_read_b32 v10, v41 offset:4
  s_mov_b32 s61, 3
  s_waitcnt lgkmcnt(0)
  v_readfirstlane_b32 s66, v42
  v_cmp_ne_u32 vcc, 1, v10
  s_cbranch_vccz L_ready
  s_add_u32 s15, s46, s60
  s_sub_u32 s25, s15, s6
  s_mul_i32 s25, s25, s7
  s_lshr_b32 s25, s25, 12
  s_mul_i32 s25, s25, s8
  s_add_u32 s25, s25, s9
  s_cmp_lt_u32 s15, 384
  s_cselect_b32 s25, s25, 0
  s_add_u32 s25, s25, s15
  s_add_u32 s25, s25, s24
  s_and_b32 s25, s25, 511
  s_mul_i32 s25, s25, 3072
  s_waitcnt vmcnt(4)
  buffer_load_dwordx4 v[84:87], v1, s[28:31], s25 offen offset:0 nt
  s_waitcnt vmcnt(4)
  buffer_load_dwordx4 v[88:91], v1, s[28:31], s25 offen offset:128 nt
  s_waitcnt vmcnt(4)
  buffer_load_dwordx4 v[92:95], v1, s[28:31], s25 offen offset:256 nt
  v_lshl_add_u32 v219, s15, 5, v40
  s_mov_b32 s60, s66
  s_mov_b64 exec, 1
  ds_add_rtn_u32 v42, v41, v46 offset:20
  s_mov_b64 exec, -1
  ds_read_b32 v10, v41 offset:4
  s_mov_b32 s61, 4
  s_waitcnt lgkmcnt(0)
  v_readfirstlane_b32 s66, v42
  v_cmp_ne_u32 vcc, 1, v10
  s_cbranch_vccz L_ready
  s_add_u32 s15, s46, s60
  s_sub_u32 s25, s15, s6
  s_mul_i32 s25, s25, s7
  s_lshr_b32 s25, s25, 12
  s_mul_i32 s25, s25, s8
  s_add_u32 s25, s25, s9
  s_cmp_lt_u32 s15, 384
  s_cselect_b32 s25, s25, 0
  s_add_u32 s25, s25, s15
  s_add_u32 s25, s25, s24
  s_and_b32 s25, s25, 511
  s_mul_i32 s25, s25, 3072
  s_waitcnt vmcnt(4)
  buffer_load_dwordx4 v[96:99], v1, s[28:31], s25 offen offset:0 nt
  s_waitcnt vmcnt(4)
  buffer_load_dwordx4 v[100:103], v1, s[28:31], s25 offen offset:128 nt
  s_waitcnt vmcnt(4)
  buffer_load_dwordx4 v[104:107], v1, s[28:31], s25 offen offset:256 nt
  v_lshl_add_u32 v220, s15, 5, v40
  s_mov_b32 s60, s66
  s_mov_b64 exec, 1
  ds_add_rtn_u32 v42, v41, v46 offset:20
  s_mov_b64 exec, -1
  ds_read_b32 v10, v41 offset:4
  s_mov_b32 s61, 5
  s_waitcnt lgkmcnt(0)
  v_readfirstlane_b32 s66, v42
  v_cmp_ne_u32 vcc, 1, v10
  s_cbranch_vccz L_ready
  s_add_u32 s15, s46, s60
  s_sub_u32 s25, s15, s6
  s_mul_i32 s25, s25, s7
  s_lshr_b32 s25, s25, 12
  s_mul_i32 s25, s25, s8
  s_add_u32 s25, s25, s9
  s_cmp_lt_u32 s15, 384
  s_cselect_b32 s25, s25, 0
  s_add_u32 s25, s25, s15
  s_add_u32 s25, s25, s24
  s_and_b32 s25, s25, 511
  s_mul_i32 s25, s25, 3072
  s_waitcnt vmcnt(4)
  buffer_load_dwordx4 v[108:111], v1, s[28:31], s25 offen offset:0 nt
  s_waitcnt vmcnt(4)
  buffer_load_dwordx4 v[112:115], v1, s[28:31], s25 offen offset:128 nt
  s_waitcnt vmcnt(4)
  buffer_load_dwordx4 v[116:119], v1, s[28:31], s25 offen offset:256 nt
  v_lshl_add_u32 v221, s15, 5, v40
  s_mov_b32 s60, s66
  s_mov_b64 exec, 1
  ds_add_rtn_u32 v42, v41, v46 offset:20
  s_mov_b64 exec, -1
  ds_read_b32 v10, v41 offset:4
  s_mov_b32 s61, 6
  s_waitcnt lgkmcnt(0)
  v_readfirstlane_b32 s66, v42
  v_cmp_ne_u32 vcc, 1, v10
  s_cbranch_vccz L_ready
  s_add_u32 s15, s46, s60
  s_sub_u32 s25, s15, s6
  s_mul_i32 s25, s25, s7
  s_lshr_b32 s25, s25, 12
  s_mul_i32 s25, s25, s8
  s_add_u32 s25, s25, s9
  s_cmp_lt_u32 s15, 384
  s_cselect_b32 s25, s25, 0
  s_add_u32 s25, s25, s15
  s_add_u32 s25, s25, s24
  s_and_b32 s25, s25, 511
  s_mul_i32 s25, s25, 3072
  s_waitcnt vmcnt(4)
  buffer_load_dwordx4 v[120:123], v1, s[28:31], s25 offen offset:0 nt
  s_waitcnt vmcnt(4)
  buffer_load_dwordx4 v[124:127], v1, s[28:31], s25 offen offset:128 nt
  s_waitcnt vmcnt(4)
  buffer_load_dwordx4 v[128:131], v1, s[28:31], s25 offen offset:256 nt
  v_lshl_add_u32 v222, s15, 5, v40
  s_mov_b32 s60, s66
  s_mov_b64 exec, 1
  ds_add_rtn_u32 v42, v41, v46 offset:20
  s_mov_b64 exec, -1
  ds_read_b32 v10, v41 offset:4
  s_mov_b32 s61, 7
  s_waitcnt lgkmcnt(0)
  v_readfirstlane_b32 s66, v42
  v_cmp_ne_u32 vcc, 1, v10
  s_cbranch_vccz L_ready
  s_add_u32 s15, s46, s60
  s_sub_u32 s25, s15, s6
  s_mul_i32 s25, s25, s7
  s_lshr_b32 s25, s25, 12
  s_mul_i32 s25, s25, s8
  s_add_u32 s25, s25, s9
  s_cmp_lt_u32 s15, 384
  s_cselect_b32 s25, s25, 0
  s_add_u32 s25, s25, s15
  s_add_u32 s25, s25, s24
  s_and_b32 s25, s25, 511
  s_mul_i32 s25, s25, 3072
  s_waitcnt vmcnt(4)
  buffer_load_dwordx4 v[132:135], v1, s[28:31], s25 offen offset:0 nt
  s_waitcnt vmcnt(4)
  buffer_load_dwordx4 v[136:139], v1, s[28:31], s25 offen offset:128 nt
  s_waitcnt vmcnt(4)
  buffer_load_dwordx4 v[140:143], v1, s[28:31], s25 offen offset:256 nt
  v_lshl_add_u32 v223, s15, 5, v40
  s_mov_b32 s60, s66
  s_mov_b64 exec, 1
  ds_add_rtn_u32 v42, v41, v46 offset:20
  s_mov_b64 exec, -1
  ds_read_b32 v10, v41 offset:4
  s_mov_b32 s61, 8
  s_waitcnt lgkmcnt(0)
  v_readfirstlane_b32 s66, v42
  s_branch L_pfdone
L_pstart_n:
  v_and_b32 v10, 1, v0
  v_lshlrev_b32 v10, 4, v10
  v_mov_b32 v11, 0xffff
  v_lshlrev_b32 v10, v10, v11
  v_lshrrev_b32 v11, 1, v43
  v_cmp_eq_u32 vcc, 0, v11
  v_cmp_eq_u32 s[66:67], 1, v11
  v_mov_b32 v6, 0xff800000
  v_mov_b32 v7, 0x7f800000
  v_cndmask_b32 v2, 0, v10, vcc
  v_cndmask_b32 v3, 0, v10, s[66:67]
  v_cmp_eq_u32 vcc, 2, v11
  v_cmp_eq_u32 s[66:67], 3, v11
  v_mov_b32 v8, 0
  v_mov_b32 v46, 1
  v_cndmask_b32 v4, 0, v10, vcc
  v_cndmask_b32 v5, 0, v10, s[66:67]
  v_mov_b32 v16, 0
  v_mov_b32 v17, 0
  v_mov_b32 v18, 0
  v_mov_b32 v19, 0
  v_mov_b32 v20, 0
  v_mov_b32 v21, 0
  v_mov_b32 v22, 0
  v_mov_b32 v23, 0
  v_mov_b32 v24, 0
  v_mov_b32 v25, 0
  v_mov_b32 v26, 0
  v_mov_b32 v27, 0
  s_waitcnt lgkmcnt(0)
  s_load_dword s55, s[26:27], 0
  s_add_u32 s28, s6, s65
  s_addc_u32 s29, s7, 0
  s_mov_b32 s30, 1572864
  s_mov_b32 s31, 0x20000
  s_add_u32 s32, s8, s65
  s_addc_u32 s33, s9, 0
  s_mov_b32 s34, 1572864
  s_mov_b32 s35, 0x20000
  s_mov_b32 s36, s26
  s_mov_b32 s37, s27
  s_mov_b32 s38, 1507328
  s_mov_b32 s39, 0x20000
  s_barrier
L_pfn:
  s_mov_b32 s60, s48
  s_add_u32 s66, s60, 7
  s_mul_i32 s45, s69, 0
  s_add_u32 s45, s45, 384
  s_sub_u32 s46, s62, 0
  v_lshrrev_b32 v40, 3, v0
  v_lshlrev_b32 v40, 2, v40
  v_add_u32 v40, 143872, v40
  s_mov_b32 s6, s62
  s_mov_b32 s7, 1366
  s_mov_b32 s8, 9
  s_mul_i32 s9, s62, 128
  s_lshr_b32 s9, s9, 12
  s_sub_u32 s9, s9, s62
  s_add_u32 s15, s46, s60
  s_sub_u32 s25, s15, s6
  s_mul_i32 s25, s25, s7
  s_lshr_b32 s25, s25, 12
  s_mul_i32 s25, s25, s8
  s_add_u32 s25, s25, s9
  s_cmp_lt_u32 s15, 384
  s_cselect_b32 s25, s25, 0
  s_add_u32 s25, s25, s15
  s_add_u32 s25, s25, s24
  s_and_b32 s25, s25, 511
  s_mul_i32 s25, s25, 3072
  buffer_load_dwordx4 v[48:51], v1, s[28:31], s25 offen offset:0 nt
  buffer_load_dwordx4 v[52:55], v1, s[28:31], s25 offen offset:128 nt
  buffer_load_dwordx4 v[56:59], v1, s[28:31], s25 offen offset:256 nt
  v_lshl_add_u32 v216, s15, 5, v40
  s_mov_b32 s60, s66
  s_add_u32 s66, s66, 7
  s_add_u32 s15, s46, s60
  s_sub_u32 s25, s15, s6
  s_mul_i32 s25, s25, s7
  s_lshr_b32 s25, s25, 12
  s_mul_i32 s25, s25, s8
  s_add_u32 s25, s25, s9
  s_cmp_lt_u32 s15, 384
  s_cselect_b32 s25, s25, 0
  s_add_u32 s25, s25, s15
  s_add_u32 s25, s25, s24
  s_and_b32 s25, s25, 511
  s_mul_i32 s25, s25, 3072
  buffer_load_dwordx4 v[60:63], v1, s[28:31], s25 offen offset:0 nt
  buffer_load_dwordx4 v[64:67], v1, s[28:31], s25 offen offset:128 nt
  s_waitcnt vmcnt(4)
  buffer_load_dwordx4 v[68:71], v1, s[28:31], s25 offen offset:256 nt
  v_lshl_add_u32 v217, s15, 5, v40
  s_mov_b32 s60, s66
  s_add_u32 s66, s66, 7
  s_add_u32 s15, s46, s60
  s_sub_u32 s25, s15, s6
  s_mul_i32 s25, s25, s7
  s_lshr_b32 s25, s25, 12
  s_mul_i32 s25, s25, s8
  s_add_u32 s25, s25, s9
  s_cmp_lt_u32 s15, 384
  s_cselect_b32 s25, s25, 0
  s_add_u32 s25, s25, s15
  s_add_u32 s25, s25, s24
  s_and_b32 s25, s25, 511
  s_mul_i32 s25, s25, 3072
  s_waitcnt vmcnt(4)
  buffer_load_dwordx4 v[72:75], v1, s[28:31], s25 offen offset:0 nt
  s_waitcnt vmcnt(4)
  buffer_load_dwordx4 v[76:79], v1, s[28:31], s25 offen offset:128 nt
  s_waitcnt vmcnt(4)
  buffer_load_dwordx4 v[80:83], v1, s[28:31], s25 offen offset:256 nt
  v_lshl_add_u32 v218, s15, 5, v40
  s_mov_b32 s60, s66
  s_mov_b64 exec, 1
  ds_add_rtn_u32 v42, v41, v46 offset:20
  s_mov_b64 exec, -1
  ds_read_b32 v10, v41 offset:4
  s_mov_b32 s61, 3
  s_waitcnt lgkmcnt(0)
  v_readfirstlane_b32 s66, v42
  v_cmp_ne_u32 vcc, 1, v10
  s_cbranch_vccz L_ready
  s_add_u32 s15, s46, s60
  s_sub_u32 s25, s15, s6
  s_mul_i32 s25, s25, s7
  s_lshr_b32 s25, s25, 12
  s_mul_i32 s25, s25, s8
  s_add_u32 s25, s25, s9
  s_cmp_lt_u32 s15, 384
  s_cselect_b32 s25, s25, 0
  s_add_u32 s25, s25, s15
  s_add_u32 s25, s25, s24
  s_and_b32 s25, s25, 511
  s_mul_i32 s25, s25, 3072
  s_waitcnt vmcnt(4)
  buffer_load_dwordx4 v[84:87], v1, s[28:31], s25 offen offset:0 nt
  s_waitcnt vmcnt(4)
  buffer_load_dwordx4 v[88:91], v1, s[28:31], s25 offen offset:128 nt
  s_waitcnt vmcnt(4)
  buffer_load_dwordx4 v[92:95], v1, s[28:31], s25 offen offset:256 nt
  v_lshl_add_u32 v219, s15, 5, v40
  s_mov_b32 s60, s66
  s_mov_b64 exec, 1
  ds_add_rtn_u32 v42, v41, v46 offset:20
  s_mov_b64 exec, -1
  ds_read_b32 v10, v41 offset:4
  s_mov_b32 s61, 4
  s_waitcnt lgkmcnt(0)
  v_readfirstlane_b32 s66, v42
  v_cmp_ne_u32 vcc, 1, v10
  s_cbranch_vccz L_ready
  s_add_u32 s15, s46, s60
  s_sub_u32 s25, s15, s6
  s_mul_i32 s25, s25, s7
  s_lshr_b32 s25, s25, 12
  s_mul_i32 s25, s25, s8
  s_add_u32 s25, s25, s9
  s_cmp_lt_u32 s15, 384
  s_cselect_b32 s25, s25, 0
  s_add_u32 s25, s25, s15
  s_add_u32 s25, s25, s24
  s_and_b32 s25, s25, 511
  s_mul_i32 s25, s25, 3072
  s_waitcnt vmcnt(4)
  buffer_load_dwordx4 v[96:99], v1, s[28:31], s25 offen offset:0 nt
  s_waitcnt vmcnt(4)
  buffer_load_dwordx4 v[100:103], v1, s[28:31], s25 offen offset:128 nt
  s_waitcnt vmcnt(4)
  buffer_load_dwordx4 v[104:107], v1, s[28:31], s25 offen offset:256 nt
  v_lshl_add_u32 v220, s15, 5, v40
  s_mov_b32 s60, s66
  s_mov_b64 exec, 1
  ds_add_rtn_u32 v42, v41, v46 offset:20
  s_mov_b64 exec, -1
  ds_read_b32 v10, v41 offset:4
  s_mov_b32 s61, 5
  s_waitcnt lgkmcnt(0)
  v_readfirstlane_b32 s66, v42
  v_cmp_ne_u32 vcc, 1, v10
  s_cbranch_vccz L_ready
  s_add_u32 s15, s46, s60
  s_sub_u32 s25, s15, s6
  s_mul_i32 s25, s25, s7
  s_lshr_b32 s25, s25, 12
  s_mul_i32 s25, s25, s8
  s_add_u32 s25, s25, s9
  s_cmp_lt_u32 s15, 384
  s_cselect_b32 s25, s25, 0
  s_add_u32 s25, s25, s15
  s_add_u32 s25, s25, s24
  s_and_b32 s25, s25, 511
  s_mul_i32 s25, s25, 3072
  s_waitcnt vmcnt(4)
  buffer_load_dwordx4 v[108:111], v1, s[28:31], s25 offen offset:0 nt
  s_waitcnt vmcnt(4)
  buffer_load_dwordx4 v[112:115], v1, s[28:31], s25 offen offset:128 nt
  s_waitcnt vmcnt(4)
  buffer_load_dwordx4 v[116:119], v1, s[28:31], s25 offen offset:256 nt
  v_lshl_add_u32 v221, s15, 5, v40
  s_mov_b32 s60, s66
  s_mov_b64 exec, 1
  ds_add_rtn_u32 v42, v41, v46 offset:20
  s_mov_b64 exec, -1
  ds_read_b32 v10, v41 offset:4
  s_mov_b32 s61, 6
  s_waitcnt lgkmcnt(0)
  v_readfirstlane_b32 s66, v42
  v_cmp_ne_u32 vcc, 1, v10
  s_cbranch_vccz L_ready
  s_add_u32 s15, s46, s60
  s_sub_u32 s25, s15, s6
  s_mul_i32 s25, s25, s7
  s_lshr_b32 s25, s25, 12
  s_mul_i32 s25, s25, s8
  s_add_u32 s25, s25, s9
  s_cmp_lt_u32 s15, 384
  s_cselect_b32 s25, s25, 0
  s_add_u32 s25, s25, s15
  s_add_u32 s25, s25, s24
  s_and_b32 s25, s25, 511
  s_mul_i32 s25, s25, 3072
  s_waitcnt vmcnt(4)
  buffer_load_dwordx4 v[120:123], v1, s[28:31], s25 offen offset:0 nt
  s_waitcnt vmcnt(4)
  buffer_load_dwordx4 v[124:127], v1, s[28:31], s25 offen offset:128 nt
  s_waitcnt vmcnt(4)
  buffer_load_dwordx4 v[128:131], v1, s[28:31], s25 offen offset:256 nt
  v_lshl_add_u32 v222, s15, 5, v40
  s_mov_b32 s60, s66
  s_mov_b64 exec, 1
  ds_add_rtn_u32 v42, v41, v46 offset:20
  s_mov_b64 exec, -1
  ds_read_b32 v10, v41 offset:4
  s_mov_b32 s61, 7
  s_waitcnt lgkmcnt(0)
  v_readfirstlane_b32 s66, v42
  v_cmp_ne_u32 vcc, 1, v10
  s_cbranch_vccz L_ready
  s_add_u32 s15, s46, s60
  s_sub_u32 s25, s15, s6
  s_mul_i32 s25, s25, s7
  s_lshr_b32 s25, s25, 12
  s_mul_i32 s25, s25, s8
  s_add_u32 s25, s25, s9
  s_cmp_lt_u32 s15, 384
  s_cselect_b32 s25, s25, 0
  s_add_u32 s25, s25, s15
  s_add_u32 s25, s25, s24
  s_and_b32 s25, s25, 511
  s_mul_i32 s25, s25, 3072
  s_waitcnt vmcnt(4)
  buffer_load_dwordx4 v[132:135], v1, s[28:31], s25 offen offset:0 nt
  s_waitcnt vmcnt(4)
  buffer_load_dwordx4 v[136:139], v1, s[28:31], s25 offen offset:128 nt
  s_waitcnt vmcnt(4)
  buffer_load_dwordx4 v[140:143], v1, s[28:31], s25 offen offset:256 nt
  v_lshl_add_u32 v223, s15, 5, v40
  s_mov_b32 s60, s66
  s_mov_b64 exec, 1
  ds_add_rtn_u32 v42, v41, v46 offset:20
  s_mov_b64 exec, -1
  ds_read_b32 v10, v41 offset:4
  s_mov_b32 s61, 8
  s_waitcnt lgkmcnt(0)
  v_readfirstlane_b32 s66, v42
L_pfdone:
L_qw_p:
  ds_read_b32 v10, v41 offset:4
  s_waitcnt lgkmcnt(0)
  v_cmp_ne_u32 vcc, 1, v10
  s_cbranch_vccnz L_qw_p
L_ready:
  v_lshlrev_b32 v9, 4, v43
  v_add_u32 v9, 134144, v9
  ds_read_b128 v[28:31], v9
  ds_read_b128 v[32:35], v9 offset:128
  ds_read_b128 v[36:39], v9 offset:256
  s_cmp_eq_u32 s48, 3
  s_cbranch_scc1 L_hastag
  s_mul_i32 s3, s55, 1664525
  s_add_u32 s3, s3, 1013904223
  s_or_b32 s3, s3, 0x01010101
  s_xor_b32 s55, s55, s3
  s_and_b32 s56, s55, 0xff
  s_bfe_u32 s57, s55, 0x80008
  s_bfe_u32 s58, s55, 0x80010
  s_lshr_b32 s59, s55, 24
L_hastag:
  s_sub_u32 s44, s64, s46
  s_add_u32 s47, s62, s48
  s_add_u32 s14, s47, 14
  s_mov_b32 s40, s28
  s_mov_b32 s41, s29
  s_mov_b32 s42, s30
  s_mov_b32 s43, s31
  s_waitcnt vmcnt(6) lgkmcnt(0)
  v_dot2_f32_bf16 v9, v48, v28, 0
  v_dot2_f32_bf16 v9, v49, v29, v9
  v_dot2_f32_bf16 v9, v50, v30, v9
  v_dot2_f32_bf16 v9, v51, v31, v9
  s_add_u32 s15, s46, s60
  s_cmp_lt_u32 s15, 424
  s_cselect_b32 s15, s15, s47
  s_cselect_b32 s40, s28, s32
  s_cselect_b32 s41, s29, s33
  s_cselect_b32 s3, 0, 7
  s_add_u32 s47, s47, s3
  s_sub_u32 s25, s15, s6
  s_mul_i32 s25, s25, s7
  s_lshr_b32 s25, s25, 12
  s_mul_i32 s25, s25, s8
  s_add_u32 s25, s25, s9
  s_cmp_lt_u32 s15, 384
  s_cselect_b32 s25, s25, 0
  s_add_u32 s25, s25, s15
  s_add_u32 s25, s25, s24
  s_and_b32 s25, s25, 511
  s_mul_i32 s25, s25, 3072
  v_dot2_f32_bf16 v9, v52, v32, v9
  v_dot2_f32_bf16 v9, v53, v33, v9
  v_dot2_f32_bf16 v9, v54, v34, v9
  v_dot2_f32_bf16 v9, v55, v35, v9
  v_dot2_f32_bf16 v9, v56, v36, v9
  v_dot2_f32_bf16 v9, v57, v37, v9
  v_dot2_f32_bf16 v9, v58, v38, v9
  v_dot2_f32_bf16 v9, v59, v39, v9
  buffer_load_dwordx4 v[48:51], v1, s[40:43], s25 offen offset:0 nt
  buffer_load_dwordx4 v[52:55], v1, s[40:43], s25 offen offset:128 nt
  buffer_load_dwordx4 v[56:59], v1, s[40:43], s25 offen offset:256 nt
  v_add_f32_dpp v9, v9, v9 quad_perm:[1,0,3,2] row_mask:0xf bank_mask:0xf
  s_nop 1
  v_add_f32_dpp v9, v9, v9 quad_perm:[2,3,0,1] row_mask:0xf bank_mask:0xf
  s_nop 1
  v_add_f32_dpp v9, v9, v9 row_half_mirror row_mask:0xf bank_mask:0xf
  v_cvt_pk_bf16_f32 v9, v9, v9
  v_lshlrev_b32 v9, 16, v9
  v_mul_f32 v9, 0x3d93cd3a, v9
  v_cvt_pk_bf16_f32 v9, v9, v9
  v_lshlrev_b32 v9, 16, v9
  ds_write_b32 v216, v9
  v_lshl_add_u32 v216, s15, 5, v40
  s_mov_b32 s60, s66
  s_waitcnt vmcnt(6)
  v_dot2_f32_bf16 v9, v60, v28, 0
  v_dot2_f32_bf16 v9, v61, v29, v9
  v_dot2_f32_bf16 v9, v62, v30, v9
  v_dot2_f32_bf16 v9, v63, v31, v9
  s_add_u32 s15, s46, s60
  s_cmp_ge_u32 s60, s44
  s_cbranch_scc1 L_klook2
L_kback2:
  s_cmp_lt_u32 s15, 424
  s_cselect_b32 s15, s15, s47
  s_cselect_b32 s40, s28, s32
  s_cselect_b32 s41, s29, s33
  s_cselect_b32 s3, 0, 7
  s_add_u32 s47, s47, s3
  s_sub_u32 s25, s15, s6
  s_mul_i32 s25, s25, s7
  s_lshr_b32 s25, s25, 12
  s_mul_i32 s25, s25, s8
  s_add_u32 s25, s25, s9
  s_cmp_lt_u32 s15, 384
  s_cselect_b32 s25, s25, 0
  s_add_u32 s25, s25, s15
  s_add_u32 s25, s25, s24
  s_and_b32 s25, s25, 511
  s_mul_i32 s25, s25, 3072
  v_dot2_f32_bf16 v9, v64, v32, v9
  v_dot2_f32_bf16 v9, v65, v33, v9
  v_dot2_f32_bf16 v9, v66, v34, v9
  v_dot2_f32_bf16 v9, v67, v35, v9
  v_dot2_f32_bf16 v9, v68, v36, v9
  v_dot2_f32_bf16 v9, v69, v37, v9
  v_dot2_f32_bf16 v9, v70, v38, v9
  v_dot2_f32_bf16 v9, v71, v39, v9
  buffer_load_dwordx4 v[60:63], v1, s[40:43], s25 offen offset:0 nt
  buffer_load_dwordx4 v[64:67], v1, s[40:43], s25 offen offset:128 nt
  buffer_load_dwordx4 v[68:71], v1, s[40:43], s25 offen offset:256 nt
  v_add_f32_dpp v9, v9, v9 quad_perm:[1,0,3,2] row_mask:0xf bank_mask:0xf
  s_nop 1
  v_add_f32_dpp v9, v9, v9 quad_perm:[2,3,0,1] row_mask:0xf bank_mask:0xf
  s_nop 1
  v_add_f32_dpp v9, v9, v9 row_half_mirror row_mask:0xf bank_mask:0xf
  v_cvt_pk_bf16_f32 v9, v9, v9
  v_lshlrev_b32 v9, 16, v9
  v_mul_f32 v9, 0x3d93cd3a, v9
  v_cvt_pk_bf16_f32 v9, v9, v9
  v_lshlrev_b32 v9, 16, v9
  ds_write_b32 v217, v9
  v_lshl_add_u32 v217, s15, 5, v40
  s_mov_b32 s60, s66
  s_waitcnt vmcnt(6)
  v_dot2_f32_bf16 v9, v72, v28, 0
  v_dot2_f32_bf16 v9, v73, v29, v9
  v_dot2_f32_bf16 v9, v74, v30, v9
  v_dot2_f32_bf16 v9, v75, v31, v9
  v_dot2_f32_bf16 v9, v76, v32, v9
  v_dot2_f32_bf16 v9, v77, v33, v9
  v_dot2_f32_bf16 v9, v78, v34, v9
  v_dot2_f32_bf16 v9, v79, v35, v9
  v_dot2_f32_bf16 v9, v80, v36, v9
  v_dot2_f32_bf16 v9, v81, v37, v9
  v_dot2_f32_bf16 v9, v82, v38, v9
  v_dot2_f32_bf16 v9, v83, v39, v9
  s_nop 2
  v_add_f32_dpp v9, v9, v9 quad_perm:[1,0,3,2] row_mask:0xf bank_mask:0xf
  s_nop 1
  v_add_f32_dpp v9, v9, v9 quad_perm:[2,3,0,1] row_mask:0xf bank_mask:0xf
  s_nop 1
  v_add_f32_dpp v9, v9, v9 row_half_mirror row_mask:0xf bank_mask:0xf
  v_cvt_pk_bf16_f32 v9, v9, v9
  v_lshlrev_b32 v9, 16, v9
  v_mul_f32 v9, 0x3d93cd3a, v9
  v_cvt_pk_bf16_f32 v9, v9, v9
  v_lshlrev_b32 v9, 16, v9
  ds_write_b32 v218, v9
  s_cmp_eq_u32 s61, 3
  s_cbranch_scc1 L_k0
  v_dot2_f32_bf16 v9, v84, v28, 0
  v_dot2_f32_bf16 v9, v85, v29, v9
  v_dot2_f32_bf16 v9, v86, v30, v9
  v_dot2_f32_bf16 v9, v87, v31, v9
  v_dot2_f32_bf16 v9, v88, v32, v9
  v_dot2_f32_bf16 v9, v89, v33, v9
  v_dot2_f32_bf16 v9, v90, v34, v9
  v_dot2_f32_bf16 v9, v91, v35, v9
  v_dot2_f32_bf16 v9, v92, v36, v9
  v_dot2_f32_bf16 v9, v93, v37, v9
  v_dot2_f32_bf16 v9, v94, v38, v9
  v_dot2_f32_bf16 v9, v95, v39, v9
  s_nop 2
  v_add_f32_dpp v9, v9, v9 quad_perm:[1,0,3,2] row_mask:0xf bank_mask:0xf
  s_nop 1
  v_add_f32_dpp v9, v9, v9 quad_perm:[2,3,0,1] row_mask:0xf bank_mask:0xf
  s_nop 1
  v_add_f32_dpp v9, v9, v9 row_half_mirror row_mask:0xf bank_mask:0xf
  v_cvt_pk_bf16_f32 v9, v9, v9
  v_lshlrev_b32 v9, 16, v9
  v_mul_f32 v9, 0x3d93cd3a, v9
  v_cvt_pk_bf16_f32 v9, v9, v9
  v_lshlrev_b32 v9, 16, v9
  ds_write_b32 v219, v9
  s_cmp_eq_u32 s61, 4
  s_cbranch_scc1 L_k0
  v_dot2_f32_bf16 v9, v96, v28, 0
  v_dot2_f32_bf16 v9, v97, v29, v9
  v_dot2_f32_bf16 v9, v98, v30, v9
  v_dot2_f32_bf16 v9, v99, v31, v9
  v_dot2_f32_bf16 v9, v100, v32, v9
  v_dot2_f32_bf16 v9, v101, v33, v9
  v_dot2_f32_bf16 v9, v102, v34, v9
  v_dot2_f32_bf16 v9, v103, v35, v9
  v_dot2_f32_bf16 v9, v104, v36, v9
  v_dot2_f32_bf16 v9, v105, v37, v9
  v_dot2_f32_bf16 v9, v106, v38, v9
  v_dot2_f32_bf16 v9, v107, v39, v9
  s_nop 2
  v_add_f32_dpp v9, v9, v9 quad_perm:[1,0,3,2] row_mask:0xf bank_mask:0xf
  s_nop 1
  v_add_f32_dpp v9, v9, v9 quad_perm:[2,3,0,1] row_mask:0xf bank_mask:0xf
  s_nop 1
  v_add_f32_dpp v9, v9, v9 row_half_mirror row_mask:0xf bank_mask:0xf
  v_cvt_pk_bf16_f32 v9, v9, v9
  v_lshlrev_b32 v9, 16, v9
  v_mul_f32 v9, 0x3d93cd3a, v9
  v_cvt_pk_bf16_f32 v9, v9, v9
  v_lshlrev_b32 v9, 16, v9
  ds_write_b32 v220, v9
  s_cmp_eq_u32 s61, 5
  s_cbranch_scc1 L_k0
  v_dot2_f32_bf16 v9, v108, v28, 0
  v_dot2_f32_bf16 v9, v109, v29, v9
  v_dot2_f32_bf16 v9, v110, v30, v9
  v_dot2_f32_bf16 v9, v111, v31, v9
  v_dot2_f32_bf16 v9, v112, v32, v9
  v_dot2_f32_bf16 v9, v113, v33, v9
  v_dot2_f32_bf16 v9, v114, v34, v9
  v_dot2_f32_bf16 v9, v115, v35, v9
  v_dot2_f32_bf16 v9, v116, v36, v9
  v_dot2_f32_bf16 v9, v117, v37, v9
  v_dot2_f32_bf16 v9, v118, v38, v9
  v_dot2_f32_bf16 v9, v119, v39, v9
  s_nop 2
  v_add_f32_dpp v9, v9, v9 quad_perm:[1,0,3,2] row_mask:0xf bank_mask:0xf
  s_nop 1
  v_add_f32_dpp v9, v9, v9 quad_perm:[2,3,0,1] row_mask:0xf bank_mask:0xf
  s_nop 1
  v_add_f32_dpp v9, v9, v9 row_half_mirror row_mask:0xf bank_mask:0xf
  v_cvt_pk_bf16_f32 v9, v9, v9
  v_lshlrev_b32 v9, 16, v9
  v_mul_f32 v9, 0x3d93cd3a, v9
  v_cvt_pk_bf16_f32 v9, v9, v9
  v_lshlrev_b32 v9, 16, v9
  ds_write_b32 v221, v9
  s_cmp_eq_u32 s61, 6
  s_cbranch_scc1 L_k0
  v_dot2_f32_bf16 v9, v120, v28, 0
  v_dot2_f32_bf16 v9, v121, v29, v9
  v_dot2_f32_bf16 v9, v122, v30, v9
  v_dot2_f32_bf16 v9, v123, v31, v9
  v_dot2_f32_bf16 v9, v124, v32, v9
  v_dot2_f32_bf16 v9, v125, v33, v9
  v_dot2_f32_bf16 v9, v126, v34, v9
  v_dot2_f32_bf16 v9, v127, v35, v9
  v_dot2_f32_bf16 v9, v128, v36, v9
  v_dot2_f32_bf16 v9, v129, v37, v9
  v_dot2_f32_bf16 v9, v130, v38, v9
  v_dot2_f32_bf16 v9, v131, v39, v9
  s_nop 2
  v_add_f32_dpp v9, v9, v9 quad_perm:[1,0,3,2] row_mask:0xf bank_mask:0xf
  s_nop 1
  v_add_f32_dpp v9, v9, v9 quad_perm:[2,3,0,1] row_mask:0xf bank_mask:0xf
  s_nop 1
  v_add_f32_dpp v9, v9, v9 row_half_mirror row_mask:0xf bank_mask:0xf
  v_cvt_pk_bf16_f32 v9, v9, v9
  v_lshlrev_b32 v9, 16, v9
  v_mul_f32 v9, 0x3d93cd3a, v9
  v_cvt_pk_bf16_f32 v9, v9, v9
  v_lshlrev_b32 v9, 16, v9
  ds_write_b32 v222, v9
  s_cmp_eq_u32 s61, 7
  s_cbranch_scc1 L_k0
  v_dot2_f32_bf16 v9, v132, v28, 0
  v_dot2_f32_bf16 v9, v133, v29, v9
  v_dot2_f32_bf16 v9, v134, v30, v9
  v_dot2_f32_bf16 v9, v135, v31, v9
  v_dot2_f32_bf16 v9, v136, v32, v9
  v_dot2_f32_bf16 v9, v137, v33, v9
  v_dot2_f32_bf16 v9, v138, v34, v9
  v_dot2_f32_bf16 v9, v139, v35, v9
  v_dot2_f32_bf16 v9, v140, v36, v9
  v_dot2_f32_bf16 v9, v141, v37, v9
  v_dot2_f32_bf16 v9, v142, v38, v9
  v_dot2_f32_bf16 v9, v143, v39, v9
  s_nop 2
  v_add_f32_dpp v9, v9, v9 quad_perm:[1,0,3,2] row_mask:0xf bank_mask:0xf
  s_nop 1
  v_add_f32_dpp v9, v9, v9 quad_perm:[2,3,0,1] row_mask:0xf bank_mask:0xf
  s_nop 1
  v_add_f32_dpp v9, v9, v9 row_half_mirror row_mask:0xf bank_mask:0xf
  v_cvt_pk_bf16_f32 v9, v9, v9
  v_lshlrev_b32 v9, 16, v9
  v_mul_f32 v9, 0x3d93cd3a, v9
  v_cvt_pk_bf16_f32 v9, v9, v9
  v_lshlrev_b32 v9, 16, v9
  ds_write_b32 v223, v9
L_k0:
  s_mov_b64 exec, 1
  ds_add_rtn_u32 v42, v41, v46 offset:20
  s_mov_b64 exec, -1
  s_waitcnt lgkmcnt(0)
  v_readfirstlane_b32 s60, v42
  s_add_u32 s15, s46, s60
  s_cmp_ge_u32 s60, s44
  s_cbranch_scc1 L_klook0
L_kback0:
  s_cmp_lt_u32 s15, 424
  s_cselect_b32 s15, s15, s47
  s_cselect_b32 s40, s28, s32
  s_cselect_b32 s41, s29, s33
  s_cselect_b32 s3, 0, 7
  s_add_u32 s47, s47, s3
  s_sub_u32 s25, s15, s6
  s_mul_i32 s25, s25, s7
  s_lshr_b32 s25, s25, 12
  s_mul_i32 s25, s25, s8
  s_add_u32 s25, s25, s9
  s_cmp_lt_u32 s15, 384
  s_cselect_b32 s25, s25, 0
  s_add_u32 s25, s25, s15
  s_add_u32 s25, s25, s24
  s_and_b32 s25, s25, 511
  s_mul_i32 s25, s25, 3072
  s_waitcnt vmcnt(3)
  v_dot2_f32_bf16 v9, v48, v28, 0
  v_dot2_f32_bf16 v9, v49, v29, v9
  v_dot2_f32_bf16 v9, v50, v30, v9
  v_dot2_f32_bf16 v9, v51, v31, v9
  v_dot2_f32_bf16 v9, v52, v32, v9
  v_dot2_f32_bf16 v9, v53, v33, v9
  v_dot2_f32_bf16 v9, v54, v34, v9
  v_dot2_f32_bf16 v9, v55, v35, v9
  v_dot2_f32_bf16 v9, v56, v36, v9
  v_dot2_f32_bf16 v9, v57, v37, v9
  v_dot2_f32_bf16 v9, v58, v38, v9
  v_dot2_f32_bf16 v9, v59, v39, v9
  buffer_load_dwordx4 v[48:51], v1, s[40:43], s25 offen offset:0 nt
  buffer_load_dwordx4 v[52:55], v1, s[40:43], s25 offen offset:128 nt
  buffer_load_dwordx4 v[56:59], v1, s[40:43], s25 offen offset:256 nt
  v_add_f32_dpp v9, v9, v9 quad_perm:[1,0,3,2] row_mask:0xf bank_mask:0xf
  s_nop 1
  v_add_f32_dpp v9, v9, v9 quad_perm:[2,3,0,1] row_mask:0xf bank_mask:0xf
  s_nop 1
  v_add_f32_dpp v9, v9, v9 row_half_mirror row_mask:0xf bank_mask:0xf
  v_cvt_pk_bf16_f32 v9, v9, v9
  v_lshlrev_b32 v9, 16, v9
  v_mul_f32 v9, 0x3d93cd3a, v9
  v_cvt_pk_bf16_f32 v9, v9, v9
  v_lshlrev_b32 v9, 16, v9
  ds_write_b32 v216, v9
  v_lshl_add_u32 v216, s15, 5, v40
  s_cmp_eq_u32 s47, s14
  s_cbranch_scc1 L_v1
L_k1:
  s_mov_b64 exec, 1
  ds_add_rtn_u32 v42, v41, v46 offset:20
  s_mov_b64 exec, -1
  s_waitcnt lgkmcnt(0)
  v_readfirstlane_b32 s60, v42
  s_add_u32 s15, s46, s60
  s_cmp_ge_u32 s60, s44
  s_cbranch_scc1 L_klook1
L_kback1:
  s_cmp_lt_u32 s15, 424
  s_cselect_b32 s15, s15, s47
  s_cselect_b32 s40, s28, s32
  s_cselect_b32 s41, s29, s33
  s_cselect_b32 s3, 0, 7
  s_add_u32 s47, s47, s3
  s_sub_u32 s25, s15, s6
  s_mul_i32 s25, s25, s7
  s_lshr_b32 s25, s25, 12
  s_mul_i32 s25, s25, s8
  s_add_u32 s25, s25, s9
  s_cmp_lt_u32 s15, 384
  s_cselect_b32 s25, s25, 0
  s_add_u32 s25, s25, s15
  s_add_u32 s25, s25, s24
  s_and_b32 s25, s25, 511
  s_mul_i32 s25, s25, 3072
  s_waitcnt vmcnt(3)
  v_dot2_f32_bf16 v9, v60, v28, 0
  v_dot2_f32_bf16 v9, v61, v29, v9
  v_dot2_f32_bf16 v9, v62, v30, v9
  v_dot2_f32_bf16 v9, v63, v31, v9
  v_dot2_f32_bf16 v9, v64, v32, v9
  v_dot2_f32_bf16 v9, v65, v33, v9
  v_dot2_f32_bf16 v9, v66, v34, v9
  v_dot2_f32_bf16 v9, v67, v35, v9
  v_dot2_f32_bf16 v9, v68, v36, v9
  v_dot2_f32_bf16 v9, v69, v37, v9
  v_dot2_f32_bf16 v9, v70, v38, v9
  v_dot2_f32_bf16 v9, v71, v39, v9
  buffer_load_dwordx4 v[60:63], v1, s[40:43], s25 offen offset:0 nt
  buffer_load_dwordx4 v[64:67], v1, s[40:43], s25 offen offset:128 nt
  buffer_load_dwordx4 v[68:71], v1, s[40:43], s25 offen offset:256 nt
  v_add_f32_dpp v9, v9, v9 quad_perm:[1,0,3,2] row_mask:0xf bank_mask:0xf
  s_nop 1
  v_add_f32_dpp v9, v9, v9 quad_perm:[2,3,0,1] row_mask:0xf bank_mask:0xf
  s_nop 1
  v_add_f32_dpp v9, v9, v9 row_half_mirror row_mask:0xf bank_mask:0xf
  v_cvt_pk_bf16_f32 v9, v9, v9
  v_lshlrev_b32 v9, 16, v9
  v_mul_f32 v9, 0x3d93cd3a, v9
  v_cvt_pk_bf16_f32 v9, v9, v9
  v_lshlrev_b32 v9, 16, v9
  ds_write_b32 v217, v9
  v_lshl_add_u32 v217, s15, 5, v40
  s_cmp_eq_u32 s47, s14
  s_cbranch_scc0 L_k0
L_v0:
  s_mov_b64 exec, 1
  ds_add_rtn_u32 v42, v41, v46 offset:0
  s_mov_b64 exec, -1
  ds_read_b32 v9, v216
  s_waitcnt lgkmcnt(0)
  v_readfirstlane_b32 s60, v42
  s_cmp_ge_u32 s60, s64
  s_cbranch_scc1 L_lookup0
L_lback0:
L_cmpv0:
  v_cmp_nle_f32 vcc, v9, v6
  s_cbranch_vccnz L_rarev0
L_backv0:
  v_fma_f32 v10, v9, s63, v7
  v_exp_f32 v10, v10
  s_nop 0
  v_cvt_pk_bf16_f32 v11, v10, v10
  v_add_f32 v8, v8, v10
  v_and_b32 v12, v2, v11
  v_and_b32 v13, v3, v11
  v_and_b32 v14, v4, v11
  v_and_b32 v15, v5, v11
  s_sub_u32 s25, s60, s6
  s_mul_i32 s25, s25, s7
  s_lshr_b32 s25, s25, 12
  s_mul_i32 s25, s25, s8
  s_add_u32 s25, s25, s9
  s_cmp_lt_u32 s60, 384
  s_cselect_b32 s25, s25, 0
  s_add_u32 s25, s25, s60
  s_add_u32 s25, s25, s24
  s_and_b32 s25, s25, 511
  s_mul_i32 s25, s25, 3072
  v_lshl_add_u32 v216, s60, 5, v40
  s_cmp_ge_u32 s60, 512
  s_waitcnt vmcnt(3)
  v_mfma_f32_16x16x32_bf16 v[16:19], v[48:51], v[12:15], v[16:19]
  v_mfma_f32_16x16x32_bf16 v[20:23], v[52:55], v[12:15], v[20:23]
  v_mfma_f32_16x16x32_bf16 v[24:27], v[56:59], v[12:15], v[24:27]
  s_cbranch_scc1 L_last1
  buffer_load_dwordx4 v[48:51], v1, s[32:35], s25 offen offset:0 nt
  buffer_load_dwordx4 v[52:55], v1, s[32:35], s25 offen offset:128 nt
  buffer_load_dwordx4 v[56:59], v1, s[32:35], s25 offen offset:256 nt
L_v1:
  s_mov_b64 exec, 1
  ds_add_rtn_u32 v42, v41, v46 offset:0
  s_mov_b64 exec, -1
  ds_read_b32 v9, v217
  s_waitcnt lgkmcnt(0)
  v_readfirstlane_b32 s60, v42
  s_cmp_ge_u32 s60, s64
  s_cbranch_scc1 L_lookup1
L_lback1:
L_cmpv1:
  v_cmp_nle_f32 vcc, v9, v6
  s_cbranch_vccnz L_rarev1
L_backv1:
  v_fma_f32 v10, v9, s63, v7
  v_exp_f32 v10, v10
  s_nop 0
  v_cvt_pk_bf16_f32 v11, v10, v10
  v_add_f32 v8, v8, v10
  v_and_b32 v12, v2, v11
  v_and_b32 v13, v3, v11
  v_and_b32 v14, v4, v11
  v_and_b32 v15, v5, v11
  s_sub_u32 s25, s60, s6
  s_mul_i32 s25, s25, s7
  s_lshr_b32 s25, s25, 12
  s_mul_i32 s25, s25, s8
  s_add_u32 s25, s25, s9
  s_cmp_lt_u32 s60, 384
  s_cselect_b32 s25, s25, 0
  s_add_u32 s25, s25, s60
  s_add_u32 s25, s25, s24
  s_and_b32 s25, s25, 511
  s_mul_i32 s25, s25, 3072
  v_lshl_add_u32 v217, s60, 5, v40
  s_cmp_ge_u32 s60, 512
  s_waitcnt vmcnt(3)
  v_mfma_f32_16x16x32_bf16 v[16:19], v[60:63], v[12:15], v[16:19]
  v_mfma_f32_16x16x32_bf16 v[20:23], v[64:67], v[12:15], v[20:23]
  v_mfma_f32_16x16x32_bf16 v[24:27], v[68:71], v[12:15], v[24:27]
  s_cbranch_scc1 L_last0
  buffer_load_dwordx4 v[60:63], v1, s[32:35], s25 offen offset:0 nt
  buffer_load_dwordx4 v[64:67], v1, s[32:35], s25 offen offset:128 nt
  buffer_load_dwordx4 v[68:71], v1, s[32:35], s25 offen offset:256 nt
  s_branch L_v0
L_klook0:
  s_sub_u32 s3, s60, s44
  s_lshl_b32 s3, s3, 2
  s_add_u32 s3, s3, 160256
  v_mov_b32 v10, s3
L_kspin0:
  ds_read_b32 v42, v10
  s_waitcnt lgkmcnt(0)
  v_readfirstlane_b32 s15, v42
  s_cmp_eq_u32 s15, -1
  s_cbranch_scc1 L_kspin0
  s_branch L_kback0
L_klook1:
  s_sub_u32 s3, s60, s44
  s_lshl_b32 s3, s3, 2
  s_add_u32 s3, s3, 160256
  v_mov_b32 v10, s3
L_kspin1:
  ds_read_b32 v42, v10
  s_waitcnt lgkmcnt(0)
  v_readfirstlane_b32 s15, v42
  s_cmp_eq_u32 s15, -1
  s_cbranch_scc1 L_kspin1
  s_branch L_kback1
L_klook2:
  s_sub_u32 s3, s60, s44
  s_lshl_b32 s3, s3, 2
  s_add_u32 s3, s3, 160256
  v_mov_b32 v10, s3
L_kspin2:
  ds_read_b32 v42, v10
  s_waitcnt lgkmcnt(0)
  v_readfirstlane_b32 s15, v42
  s_cmp_eq_u32 s15, -1
  s_cbranch_scc1 L_kspin2
  s_branch L_kback2
L_lookup0:
  s_sub_u32 s3, s60, s64
  s_lshl_b32 s3, s3, 2
  s_add_u32 s3, s3, 139776
  v_mov_b32 v10, s3
L_lspin0:
  ds_read_b32 v42, v10
  s_waitcnt lgkmcnt(0)
  v_readfirstlane_b32 s60, v42
  s_cmp_eq_u32 s60, -1
  s_cbranch_scc1 L_lspin0
  s_cmp_ge_u32 s60, 512
  s_bitset0_b32 s60, 15
  s_cbranch_scc1 L_lback0
L_cmpt0:
  v_cmp_nle_f32 vcc, v9, v6
  s_cbranch_vccnz L_raret0
L_backt0:
  v_fma_f32 v10, v9, s63, v7
  v_exp_f32 v10, v10
  s_nop 0
  v_cvt_pk_bf16_f32 v11, v10, v10
  v_add_f32 v8, v8, v10
  v_and_b32 v12, v2, v11
  v_and_b32 v13, v3, v11
  v_and_b32 v14, v4, v11
  v_and_b32 v15, v5, v11
  s_add_u32 s25, s60, s24
  s_and_b32 s25, s25, 511
  s_mul_i32 s25, s25, 3072
  s_waitcnt vmcnt(3)
  v_mfma_f32_16x16x32_bf16 v[16:19], v[48:51], v[12:15], v[16:19]
  v_mfma_f32_16x16x32_bf16 v[20:23], v[52:55], v[12:15], v[20:23]
  v_mfma_f32_16x16x32_bf16 v[24:27], v[56:59], v[12:15], v[24:27]
  buffer_load_dwordx4 v[48:51], v1, s[28:31], s25 offen offset:0 nt
  buffer_load_dwordx4 v[52:55], v1, s[28:31], s25 offen offset:128 nt
  buffer_load_dwordx4 v[56:59], v1, s[28:31], s25 offen offset:256 nt
  ds_read_b32 v9, v217
  s_waitcnt lgkmcnt(0)
L_cmpu0:
  v_cmp_nle_f32 vcc, v9, v6
  s_cbranch_vccnz L_rareu0
L_backu0:
  v_fma_f32 v10, v9, s63, v7
  v_exp_f32 v10, v10
  s_nop 0
  v_cvt_pk_bf16_f32 v11, v10, v10
  v_add_f32 v8, v8, v10
  v_and_b32 v12, v2, v11
  v_and_b32 v13, v3, v11
  v_and_b32 v14, v4, v11
  v_and_b32 v15, v5, v11
L_mv0:
  s_waitcnt vmcnt(3)
  s_nop 0
  v_mfma_f32_16x16x32_bf16 v[16:19], v[60:63], v[12:15], v[16:19]
  v_mfma_f32_16x16x32_bf16 v[20:23], v[64:67], v[12:15], v[20:23]
  v_mfma_f32_16x16x32_bf16 v[24:27], v[68:71], v[12:15], v[24:27]
  buffer_load_dwordx4 v[60:63], v1, s[32:35], s25 offen offset:0 nt
  buffer_load_dwordx4 v[64:67], v1, s[32:35], s25 offen offset:128 nt
  buffer_load_dwordx4 v[68:71], v1, s[32:35], s25 offen offset:256 nt
  s_mov_b64 exec, 1
  ds_add_rtn_u32 v42, v41, v46 offset:0
  s_mov_b64 exec, -1
  s_waitcnt lgkmcnt(0)
  v_readfirstlane_b32 s60, v42
  s_sub_u32 s3, s60, s64
  s_lshl_b32 s3, s3, 2
  s_add_u32 s3, s3, 139776
  v_mov_b32 v10, s3
L_mspin0:
  ds_read_b32 v42, v10
  s_waitcnt lgkmcnt(0)
  v_readfirstlane_b32 s60, v42
  s_cmp_eq_u32 s60, -1
  s_cbranch_scc1 L_mspin0
  s_cmp_ge_u32 s60, 512
  s_cbranch_scc1 L_mlast0
  s_add_u32 s25, s60, s24
  s_and_b32 s25, s25, 511
  s_mul_i32 s25, s25, 3072
  s_waitcnt vmcnt(3)
  v_dot2_f32_bf16 v9, v48, v28, 0
  v_dot2_f32_bf16 v9, v49, v29, v9
  v_dot2_f32_bf16 v9, v50, v30, v9
  v_dot2_f32_bf16 v9, v51, v31, v9
  v_dot2_f32_bf16 v9, v52, v32, v9
  v_dot2_f32_bf16 v9, v53, v33, v9
  v_dot2_f32_bf16 v9, v54, v34, v9
  v_dot2_f32_bf16 v9, v55, v35, v9
  v_dot2_f32_bf16 v9, v56, v36, v9
  v_dot2_f32_bf16 v9, v57, v37, v9
  v_dot2_f32_bf16 v9, v58, v38, v9
  v_dot2_f32_bf16 v9, v59, v39, v9
  buffer_load_dwordx4 v[48:51], v1, s[28:31], s25 offen offset:0 nt
  buffer_load_dwordx4 v[52:55], v1, s[28:31], s25 offen offset:128 nt
  buffer_load_dwordx4 v[56:59], v1, s[28:31], s25 offen offset:256 nt
  v_add_f32_dpp v9, v9, v9 quad_perm:[1,0,3,2] row_mask:0xf bank_mask:0xf
  s_nop 1
  v_add_f32_dpp v9, v9, v9 quad_perm:[2,3,0,1] row_mask:0xf bank_mask:0xf
  s_nop 1
  v_add_f32_dpp v9, v9, v9 row_half_mirror row_mask:0xf bank_mask:0xf
  v_cvt_pk_bf16_f32 v9, v9, v9
  v_lshlrev_b32 v9, 16, v9
  v_mul_f32 v9, 0x3d93cd3a, v9
  v_cvt_pk_bf16_f32 v9, v9, v9
  v_lshlrev_b32 v9, 16, v9
L_cmpm0:
  v_cmp_nle_f32 vcc, v9, v6
  s_cbranch_vccnz L_rarem0
L_backm0:
  v_fma_f32 v10, v9, s63, v7
  v_exp_f32 v10, v10
  s_nop 0
  v_cvt_pk_bf16_f32 v11, v10, v10
  v_add_f32 v8, v8, v10
  v_and_b32 v12, v2, v11
  v_and_b32 v13, v3, v11
  v_and_b32 v14, v4, v11
  v_and_b32 v15, v5, v11
  s_branch L_mv0
L_mlast0:
  s_waitcnt vmcnt(3)
  v_dot2_f32_bf16 v9, v48, v28, 0
  v_dot2_f32_bf16 v9, v49, v29, v9
  v_dot2_f32_bf16 v9, v50, v30, v9
  v_dot2_f32_bf16 v9, v51, v31, v9
  v_dot2_f32_bf16 v9, v52, v32, v9
  v_dot2_f32_bf16 v9, v53, v33, v9
  v_dot2_f32_bf16 v9, v54, v34, v9
  v_dot2_f32_bf16 v9, v55, v35, v9
  v_dot2_f32_bf16 v9, v56, v36, v9
  v_dot2_f32_bf16 v9, v57, v37, v9
  v_dot2_f32_bf16 v9, v58, v38, v9
  v_dot2_f32_bf16 v9, v59, v39, v9
  s_nop 2
  v_add_f32_dpp v9, v9, v9 quad_perm:[1,0,3,2] row_mask:0xf bank_mask:0xf
  s_nop 1
  v_add_f32_dpp v9, v9, v9 quad_perm:[2,3,0,1] row_mask:0xf bank_mask:0xf
  s_nop 1
  v_add_f32_dpp v9, v9, v9 row_half_mirror row_mask:0xf bank_mask:0xf
  v_cvt_pk_bf16_f32 v9, v9, v9
  v_lshlrev_b32 v9, 16, v9
  v_mul_f32 v9, 0x3d93cd3a, v9
  v_cvt_pk_bf16_f32 v9, v9, v9
  v_lshlrev_b32 v9, 16, v9
  s_mov_b32 s60, 0
  s_branch L_cmpd
L_lookup1:
  s_sub_u32 s3, s60, s64
  s_lshl_b32 s3, s3, 2
  s_add_u32 s3, s3, 139776
  v_mov_b32 v10, s3
L_lspin1:
  ds_read_b32 v42, v10
  s_waitcnt lgkmcnt(0)
  v_readfirstlane_b32 s60, v42
  s_cmp_eq_u32 s60, -1
  s_cbranch_scc1 L_lspin1
  s_cmp_ge_u32 s60, 512
  s_bitset0_b32 s60, 15
  s_cbranch_scc1 L_lback1
L_cmpt1:
  v_cmp_nle_f32 vcc, v9, v6
  s_cbranch_vccnz L_raret1
L_backt1:
  v_fma_f32 v10, v9, s63, v7
  v_exp_f32 v10, v10
  s_nop 0
  v_cvt_pk_bf16_f32 v11, v10, v10
  v_add_f32 v8, v8, v10
  v_and_b32 v12, v2, v11
  v_and_b32 v13, v3, v11
  v_and_b32 v14, v4, v11
  v_and_b32 v15, v5, v11
  s_add_u32 s25, s60, s24
  s_and_b32 s25, s25, 511
  s_mul_i32 s25, s25, 3072
  s_waitcnt vmcnt(3)
  v_mfma_f32_16x16x32_bf16 v[16:19], v[60:63], v[12:15], v[16:19]
  v_mfma_f32_16x16x32_bf16 v[20:23], v[64:67], v[12:15], v[20:23]
  v_mfma_f32_16x16x32_bf16 v[24:27], v[68:71], v[12:15], v[24:27]
  buffer_load_dwordx4 v[60:63], v1, s[28:31], s25 offen offset:0 nt
  buffer_load_dwordx4 v[64:67], v1, s[28:31], s25 offen offset:128 nt
  buffer_load_dwordx4 v[68:71], v1, s[28:31], s25 offen offset:256 nt
  ds_read_b32 v9, v216
  s_waitcnt lgkmcnt(0)
L_cmpu1:
  v_cmp_nle_f32 vcc, v9, v6
  s_cbranch_vccnz L_rareu1
L_backu1:
  v_fma_f32 v10, v9, s63, v7
  v_exp_f32 v10, v10
  s_nop 0
  v_cvt_pk_bf16_f32 v11, v10, v10
  v_add_f32 v8, v8, v10
  v_and_b32 v12, v2, v11
  v_and_b32 v13, v3, v11
  v_and_b32 v14, v4, v11
  v_and_b32 v15, v5, v11
L_mv1:
  s_waitcnt vmcnt(3)
  s_nop 0
  v_mfma_f32_16x16x32_bf16 v[16:19], v[48:51], v[12:15], v[16:19]
  v_mfma_f32_16x16x32_bf16 v[20:23], v[52:55], v[12:15], v[20:23]
  v_mfma_f32_16x16x32_bf16 v[24:27], v[56:59], v[12:15], v[24:27]
  buffer_load_dwordx4 v[48:51], v1, s[32:35], s25 offen offset:0 nt
  buffer_load_dwordx4 v[52:55], v1, s[32:35], s25 offen offset:128 nt
  buffer_load_dwordx4 v[56:59], v1, s[32:35], s25 offen offset:256 nt
  s_mov_b64 exec, 1
  ds_add_rtn_u32 v42, v41, v46 offset:0
  s_mov_b64 exec, -1
  s_waitcnt lgkmcnt(0)
  v_readfirstlane_b32 s60, v42
  s_sub_u32 s3, s60, s64
  s_lshl_b32 s3, s3, 2
  s_add_u32 s3, s3, 139776
  v_mov_b32 v10, s3
L_mspin1:
  ds_read_b32 v42, v10
  s_waitcnt lgkmcnt(0)
  v_readfirstlane_b32 s60, v42
  s_cmp_eq_u32 s60, -1
  s_cbranch_scc1 L_mspin1
  s_cmp_ge_u32 s60, 512
  s_cbranch_scc1 L_mlast1
  s_add_u32 s25, s60, s24
  s_and_b32 s25, s25, 511
  s_mul_i32 s25, s25, 3072
  s_waitcnt vmcnt(3)
  v_dot2_f32_bf16 v9, v60, v28, 0
  v_dot2_f32_bf16 v9, v61, v29, v9
  v_dot2_f32_bf16 v9, v62, v30, v9
  v_dot2_f32_bf16 v9, v63, v31, v9
  v_dot2_f32_bf16 v9, v64, v32, v9
  v_dot2_f32_bf16 v9, v65, v33, v9
  v_dot2_f32_bf16 v9, v66, v34, v9
  v_dot2_f32_bf16 v9, v67, v35, v9
  v_dot2_f32_bf16 v9, v68, v36, v9
  v_dot2_f32_bf16 v9, v69, v37, v9
  v_dot2_f32_bf16 v9, v70, v38, v9
  v_dot2_f32_bf16 v9, v71, v39, v9
  buffer_load_dwordx4 v[60:63], v1, s[28:31], s25 offen offset:0 nt
  buffer_load_dwordx4 v[64:67], v1, s[28:31], s25 offen offset:128 nt
  buffer_load_dwordx4 v[68:71], v1, s[28:31], s25 offen offset:256 nt
  v_add_f32_dpp v9, v9, v9 quad_perm:[1,0,3,2] row_mask:0xf bank_mask:0xf
  s_nop 1
  v_add_f32_dpp v9, v9, v9 quad_perm:[2,3,0,1] row_mask:0xf bank_mask:0xf
  s_nop 1
  v_add_f32_dpp v9, v9, v9 row_half_mirror row_mask:0xf bank_mask:0xf
  v_cvt_pk_bf16_f32 v9, v9, v9
  v_lshlrev_b32 v9, 16, v9
  v_mul_f32 v9, 0x3d93cd3a, v9
  v_cvt_pk_bf16_f32 v9, v9, v9
  v_lshlrev_b32 v9, 16, v9
L_cmpm1:
  v_cmp_nle_f32 vcc, v9, v6
  s_cbranch_vccnz L_rarem1
L_backm1:
  v_fma_f32 v10, v9, s63, v7
  v_exp_f32 v10, v10
  s_nop 0
  v_cvt_pk_bf16_f32 v11, v10, v10
  v_add_f32 v8, v8, v10
  v_and_b32 v12, v2, v11
  v_and_b32 v13, v3, v11
  v_and_b32 v14, v4, v11
  v_and_b32 v15, v5, v11
  s_branch L_mv1
L_mlast1:
  s_waitcnt vmcnt(3)
  v_dot2_f32_bf16 v9, v60, v28, 0
  v_dot2_f32_bf16 v9, v61, v29, v9
  v_dot2_f32_bf16 v9, v62, v30, v9
  v_dot2_f32_bf16 v9, v63, v31, v9
  v_dot2_f32_bf16 v9, v64, v32, v9
  v_dot2_f32_bf16 v9, v65, v33, v9
  v_dot2_f32_bf16 v9, v66, v34, v9
  v_dot2_f32_bf16 v9, v67, v35, v9
  v_dot2_f32_bf16 v9, v68, v36, v9
  v_dot2_f32_bf16 v9, v69, v37, v9
  v_dot2_f32_bf16 v9, v70, v38, v9
  v_dot2_f32_bf16 v9, v71, v39, v9
  s_nop 2
  v_add_f32_dpp v9, v9, v9 quad_perm:[1,0,3,2] row_mask:0xf bank_mask:0xf
  s_nop 1
  v_add_f32_dpp v9, v9, v9 quad_perm:[2,3,0,1] row_mask:0xf bank_mask:0xf
  s_nop 1
  v_add_f32_dpp v9, v9, v9 row_half_mirror row_mask:0xf bank_mask:0xf
  v_cvt_pk_bf16_f32 v9, v9, v9
  v_lshlrev_b32 v9, 16, v9
  v_mul_f32 v9, 0x3d93cd3a, v9
  v_cvt_pk_bf16_f32 v9, v9, v9
  v_lshlrev_b32 v9, 16, v9
  s_mov_b32 s60, 1
  s_branch L_cmpd
L_last1:
  v_mov_b32 v216, v217
  s_mov_b32 s47, 0
L_last0:
  ds_read_b32 v9, v216
  s_mov_b32 s60, s47
  s_waitcnt lgkmcnt(0)
L_cmpd:
  v_cmp_nle_f32 vcc, v9, v6
  s_cbranch_vccnz L_rared
L_backd:
  v_fma_f32 v10, v9, s63, v7
  v_exp_f32 v10, v10
  s_nop 0
  v_cvt_pk_bf16_f32 v11, v10, v10
  v_add_f32 v8, v8, v10
  v_and_b32 v12, v2, v11
  v_and_b32 v13, v3, v11
  v_and_b32 v14, v4, v11
  v_and_b32 v15, v5, v11
L_drain:
  v_add_f32_dpp v8, v8, v8 row_ror:8 row_mask:0xf bank_mask:0xf
  v_lshrrev_b32 v47, 5, v0
  v_bfe_u32 v10, v0, 4, 1
  v_mov_b32 v9, v8
  v_mul_u32_u24 v47, 784, v47
  v_lshl_add_u32 v10, v10, 3, v43
  v_permlane16_swap_b32 v8, v9
  v_add_f32 v8, v8, v9
  v_lshl_add_u32 v47, v10, 4, v47
  v_mov_b32 v9, v8
  s_cmp_lt_u32 s54, 128
  s_nop 0
  v_permlane32_swap_b32 v8, v9
  v_add_f32 v8, v8, v9
  v_mov_b32 v9, 1
  s_cbranch_scc1 L_wdma
  s_waitcnt vmcnt(0)
L_drain2:
  s_mov_b64 exec, 1
  ds_add_rtn_u32 v42, v41, v46 offset:16
  s_mov_b64 exec, -1
  ds_read_b32 v40, v41 offset:12
  s_cmp_eq_u32 s60, 0
  s_cbranch_scc1 L_pv1
  v_mfma_f32_16x16x32_bf16 v[16:19], v[48:51], v[12:15], v[16:19]
  v_mfma_f32_16x16x32_bf16 v[20:23], v[52:55], v[12:15], v[20:23]
  v_mfma_f32_16x16x32_bf16 v[24:27], v[56:59], v[12:15], v[24:27]
L_attn_done:
  s_waitcnt lgkmcnt(1)
  v_readfirstlane_b32 s3, v42
  s_mul_i32 s3, s3, 1568
  s_add_u32 s3, s3, 123136
  v_add_u32 v47, s3, v47
  s_mov_b32 exec_lo, 0xff00ff
  s_mov_b32 exec_hi, 0xff00ff00
  ds_write_b128 v47, v[16:19]
  ds_write_b128 v47, v[20:23] offset:256
  ds_write_b128 v47, v[24:27] offset:512
  s_mov_b64 exec, 1
  ds_write_b128 v47, v[6:9] offset:768
  s_mov_b64 exec, -1
  s_waitcnt lgkmcnt(0)
  v_readfirstlane_b32 s24, v40
  s_cmp_lt_u32 s54, 80
  s_cbranch_scc1 L_orole
  s_cmp_lt_u32 s54, 128
  s_cbranch_scc1 L_frole
  s_branch L_fin
L_nhelp:
  s_bfe_u32 s66, s54, 0x40003
  s_and_b32 s68, s54, 7
  v_lshlrev_b32 v233, 7, v0
  s_mul_i32 s65, s66, 98304
  s_mul_i32 s67, s68, 384
  s_add_u32 s65, s65, s67
  s_add_u32 s65, s65, 393216
  s_add_u32 s40, s16, s65
  s_addc_u32 s41, s17, 0
  s_mov_b32 s42, 95616
  s_mov_b32 s43, 0x20000
  s_add_u32 s44, s18, s65
  s_addc_u32 s45, s19, 0
  s_mov_b32 s46, 95616
  s_mov_b32 s47, 0x20000
  s_lshl_b32 s3, s68, 4
  s_add_u32 s3, s3, s66
  s_mul_i32 s3, s3, 15360
  s_add_u32 s32, s20, s3
  s_addc_u32 s33, s21, 0
  s_mov_b32 s34, 15360
  s_mov_b32 s35, 0x20000
  v_mul_u32_u24 v232, 43, v0
  v_lshrrev_b32 v232, 7, v232
  v_mul_u32_u24 v232, 2688, v232
  v_add_u32 v232, v232, v233
  s_mov_b32 s10, 49152
  s_mov_b32 s11, 7680
  s_mov_b32 exec_lo, 0xffffffff
  s_mov_b32 exec_hi, 0xffff
  buffer_load_dword v56, v232, s[40:43], 0 offen nt
  buffer_load_dword v88, v232, s[40:43], 0 offen sc1
  buffer_load_dword v57, v232, s[44:47], 0 offen nt
  buffer_load_dword v89, v232, s[44:47], 0 offen sc1
  buffer_load_dword v58, v232, s[40:43], s10 offen nt
  buffer_load_dword v90, v232, s[40:43], s10 offen sc1
  buffer_load_dword v59, v232, s[44:47], s10 offen nt
  buffer_load_dword v91, v232, s[44:47], s10 offen sc1
  s_mov_b32 exec_lo, 0xffffffff
  s_mov_b32 exec_hi, 0xfffffff
  s_branch L_fin
L_pv1:
  v_mfma_f32_16x16x32_bf16 v[16:19], v[60:63], v[12:15], v[16:19]
  v_mfma_f32_16x16x32_bf16 v[20:23], v[64:67], v[12:15], v[20:23]
  v_mfma_f32_16x16x32_bf16 v[24:27], v[68:71], v[12:15], v[24:27]
  s_branch L_attn_done
L_rarev0:
  v_cmp_eq_u32 vcc, -1, v9
  s_cbranch_vccz L_newv0
  ds_read_b32 v9, v216
  s_waitcnt lgkmcnt(0)
  s_branch L_cmpv0
L_newv0:
  v_max_f32_dpp v10, v9, v9 row_ror:8 row_mask:0xf bank_mask:0xf
  v_mov_b32 v11, v10
  s_nop 1
  v_permlane16_swap_b32 v10, v11
  v_max_f32 v10, v10, v11
  v_mov_b32 v11, v10
  s_nop 1
  v_permlane32_swap_b32 v10, v11
  v_max3_f32 v6, v10, v11, v6
  v_mul_f32 v10, s63, v6
  v_sub_f32 v11, -v10, v7
  v_exp_f32 v11, v11
  v_sub_f32 v7, 0, v10
  v_mul_f32 v8, v8, v11
  v_mul_f32 v16, v16, v11
  v_mul_f32 v17, v17, v11
  v_mul_f32 v18, v18, v11
  v_mul_f32 v19, v19, v11
  v_mul_f32 v20, v20, v11
  v_mul_f32 v21, v21, v11
  v_mul_f32 v22, v22, v11
  v_mul_f32 v23, v23, v11
  v_mul_f32 v24, v24, v11
  v_mul_f32 v25, v25, v11
  v_mul_f32 v26, v26, v11
  v_mul_f32 v27, v27, v11
  s_branch L_backv0
L_rarev1:
  v_cmp_eq_u32 vcc, -1, v9
  s_cbranch_vccz L_newv1
  ds_read_b32 v9, v217
  s_waitcnt lgkmcnt(0)
  s_branch L_cmpv1
L_newv1:
  v_max_f32_dpp v10, v9, v9 row_ror:8 row_mask:0xf bank_mask:0xf
  v_mov_b32 v11, v10
  s_nop 1
  v_permlane16_swap_b32 v10, v11
  v_max_f32 v10, v10, v11
  v_mov_b32 v11, v10
  s_nop 1
  v_permlane32_swap_b32 v10, v11
  v_max3_f32 v6, v10, v11, v6
  v_mul_f32 v10, s63, v6
  v_sub_f32 v11, -v10, v7
  v_exp_f32 v11, v11
  v_sub_f32 v7, 0, v10
  v_mul_f32 v8, v8, v11
  v_mul_f32 v16, v16, v11
  v_mul_f32 v17, v17, v11
  v_mul_f32 v18, v18, v11
  v_mul_f32 v19, v19, v11
  v_mul_f32 v20, v20, v11
  v_mul_f32 v21, v21, v11
  v_mul_f32 v22, v22, v11
  v_mul_f32 v23, v23, v11
  v_mul_f32 v24, v24, v11
  v_mul_f32 v25, v25, v11
  v_mul_f32 v26, v26, v11
  v_mul_f32 v27, v27, v11
  s_branch L_backv1
L_raret0:
  v_cmp_eq_u32 vcc, -1, v9
  s_cbranch_vccz L_newt0
  ds_read_b32 v9, v216
  s_waitcnt lgkmcnt(0)
  s_branch L_cmpt0
L_newt0:
  v_max_f32_dpp v10, v9, v9 row_ror:8 row_mask:0xf bank_mask:0xf
  v_mov_b32 v11, v10
  s_nop 1
  v_permlane16_swap_b32 v10, v11
  v_max_f32 v10, v10, v11
  v_mov_b32 v11, v10
  s_nop 1
  v_permlane32_swap_b32 v10, v11
  v_max3_f32 v6, v10, v11, v6
  v_mul_f32 v10, s63, v6
  v_sub_f32 v11, -v10, v7
  v_exp_f32 v11, v11
  v_sub_f32 v7, 0, v10
  v_mul_f32 v8, v8, v11
  v_mul_f32 v16, v16, v11
  v_mul_f32 v17, v17, v11
  v_mul_f32 v18, v18, v11
  v_mul_f32 v19, v19, v11
  v_mul_f32 v20, v20, v11
  v_mul_f32 v21, v21, v11
  v_mul_f32 v22, v22, v11
  v_mul_f32 v23, v23, v11
  v_mul_f32 v24, v24, v11
  v_mul_f32 v25, v25, v11
  v_mul_f32 v26, v26, v11
  v_mul_f32 v27, v27, v11
  s_branch L_backt0
L_rareu0:
  v_cmp_eq_u32 vcc, -1, v9
  s_cbranch_vccz L_newu0
  ds_read_b32 v9, v217
  s_waitcnt lgkmcnt(0)
  s_branch L_cmpu0
L_newu0:
  v_max_f32_dpp v10, v9, v9 row_ror:8 row_mask:0xf bank_mask:0xf
  v_mov_b32 v11, v10
  s_nop 1
  v_permlane16_swap_b32 v10, v11
  v_max_f32 v10, v10, v11
  v_mov_b32 v11, v10
  s_nop 1
  v_permlane32_swap_b32 v10, v11
  v_max3_f32 v6, v10, v11, v6
  v_mul_f32 v10, s63, v6
  v_sub_f32 v11, -v10, v7
  v_exp_f32 v11, v11
  v_sub_f32 v7, 0, v10
  v_mul_f32 v8, v8, v11
  v_mul_f32 v16, v16, v11
  v_mul_f32 v17, v17, v11
  v_mul_f32 v18, v18, v11
  v_mul_f32 v19, v19, v11
  v_mul_f32 v20, v20, v11
  v_mul_f32 v21, v21, v11
  v_mul_f32 v22, v22, v11
  v_mul_f32 v23, v23, v11
  v_mul_f32 v24, v24, v11
  v_mul_f32 v25, v25, v11
  v_mul_f32 v26, v26, v11
  v_mul_f32 v27, v27, v11
  s_branch L_backu0
L_rarem0:
L_newm0:
  v_max_f32_dpp v10, v9, v9 row_ror:8 row_mask:0xf bank_mask:0xf
  v_mov_b32 v11, v10
  s_nop 1
  v_permlane16_swap_b32 v10, v11
  v_max_f32 v10, v10, v11
  v_mov_b32 v11, v10
  s_nop 1
  v_permlane32_swap_b32 v10, v11
  v_max3_f32 v6, v10, v11, v6
  v_mul_f32 v10, s63, v6
  v_sub_f32 v11, -v10, v7
  v_exp_f32 v11, v11
  v_sub_f32 v7, 0, v10
  v_mul_f32 v8, v8, v11
  v_mul_f32 v16, v16, v11
  v_mul_f32 v17, v17, v11
  v_mul_f32 v18, v18, v11
  v_mul_f32 v19, v19, v11
  v_mul_f32 v20, v20, v11
  v_mul_f32 v21, v21, v11
  v_mul_f32 v22, v22, v11
  v_mul_f32 v23, v23, v11
  v_mul_f32 v24, v24, v11
  v_mul_f32 v25, v25, v11
  v_mul_f32 v26, v26, v11
  v_mul_f32 v27, v27, v11
  s_branch L_backm0
L_raret1:
  v_cmp_eq_u32 vcc, -1, v9
  s_cbranch_vccz L_newt1
  ds_read_b32 v9, v217
  s_waitcnt lgkmcnt(0)
  s_branch L_cmpt1
L_newt1:
  v_max_f32_dpp v10, v9, v9 row_ror:8 row_mask:0xf bank_mask:0xf
  v_mov_b32 v11, v10
  s_nop 1
  v_permlane16_swap_b32 v10, v11
  v_max_f32 v10, v10, v11
  v_mov_b32 v11, v10
  s_nop 1
  v_permlane32_swap_b32 v10, v11
  v_max3_f32 v6, v10, v11, v6
  v_mul_f32 v10, s63, v6
  v_sub_f32 v11, -v10, v7
  v_exp_f32 v11, v11
  v_sub_f32 v7, 0, v10
  v_mul_f32 v8, v8, v11
  v_mul_f32 v16, v16, v11
  v_mul_f32 v17, v17, v11
  v_mul_f32 v18, v18, v11
  v_mul_f32 v19, v19, v11
  v_mul_f32 v20, v20, v11
  v_mul_f32 v21, v21, v11
  v_mul_f32 v22, v22, v11
  v_mul_f32 v23, v23, v11
  v_mul_f32 v24, v24, v11
  v_mul_f32 v25, v25, v11
  v_mul_f32 v26, v26, v11
  v_mul_f32 v27, v27, v11
  s_branch L_backt1
L_rareu1:
  v_cmp_eq_u32 vcc, -1, v9
  s_cbranch_vccz L_newu1
  ds_read_b32 v9, v216
  s_waitcnt lgkmcnt(0)
  s_branch L_cmpu1
L_newu1:
  v_max_f32_dpp v10, v9, v9 row_ror:8 row_mask:0xf bank_mask:0xf
  v_mov_b32 v11, v10
  s_nop 1
  v_permlane16_swap_b32 v10, v11
  v_max_f32 v10, v10, v11
  v_mov_b32 v11, v10
  s_nop 1
  v_permlane32_swap_b32 v10, v11
  v_max3_f32 v6, v10, v11, v6
  v_mul_f32 v10, s63, v6
  v_sub_f32 v11, -v10, v7
  v_exp_f32 v11, v11
  v_sub_f32 v7, 0, v10
  v_mul_f32 v8, v8, v11
  v_mul_f32 v16, v16, v11
  v_mul_f32 v17, v17, v11
  v_mul_f32 v18, v18, v11
  v_mul_f32 v19, v19, v11
  v_mul_f32 v20, v20, v11
  v_mul_f32 v21, v21, v11
  v_mul_f32 v22, v22, v11
  v_mul_f32 v23, v23, v11
  v_mul_f32 v24, v24, v11
  v_mul_f32 v25, v25, v11
  v_mul_f32 v26, v26, v11
  v_mul_f32 v27, v27, v11
  s_branch L_backu1
L_rarem1:
L_newm1:
  v_max_f32_dpp v10, v9, v9 row_ror:8 row_mask:0xf bank_mask:0xf
  v_mov_b32 v11, v10
  s_nop 1
  v_permlane16_swap_b32 v10, v11
  v_max_f32 v10, v10, v11
  v_mov_b32 v11, v10
  s_nop 1
  v_permlane32_swap_b32 v10, v11
  v_max3_f32 v6, v10, v11, v6
  v_mul_f32 v10, s63, v6
  v_sub_f32 v11, -v10, v7
  v_exp_f32 v11, v11
  v_sub_f32 v7, 0, v10
  v_mul_f32 v8, v8, v11
  v_mul_f32 v16, v16, v11
  v_mul_f32 v17, v17, v11
  v_mul_f32 v18, v18, v11
  v_mul_f32 v19, v19, v11
  v_mul_f32 v20, v20, v11
  v_mul_f32 v21, v21, v11
  v_mul_f32 v22, v22, v11
  v_mul_f32 v23, v23, v11
  v_mul_f32 v24, v24, v11
  v_mul_f32 v25, v25, v11
  v_mul_f32 v26, v26, v11
  v_mul_f32 v27, v27, v11
  s_branch L_backm1
L_rared:
  v_cmp_eq_u32 vcc, -1, v9
  s_cbranch_vccz L_newd
  ds_read_b32 v9, v216
  s_waitcnt lgkmcnt(0)
  s_branch L_cmpd
L_newd:
  v_max_f32_dpp v10, v9, v9 row_ror:8 row_mask:0xf bank_mask:0xf
  v_mov_b32 v11, v10
  s_nop 1
  v_permlane16_swap_b32 v10, v11
  v_max_f32 v10, v10, v11
  v_mov_b32 v11, v10
  s_nop 1
  v_permlane32_swap_b32 v10, v11
  v_max3_f32 v6, v10, v11, v6
  v_mul_f32 v10, s63, v6
  v_sub_f32 v11, -v10, v7
  v_exp_f32 v11, v11
  v_sub_f32 v7, 0, v10
  v_mul_f32 v8, v8, v11
  v_mul_f32 v16, v16, v11
  v_mul_f32 v17, v17, v11
  v_mul_f32 v18, v18, v11
  v_mul_f32 v19, v19, v11
  v_mul_f32 v20, v20, v11
  v_mul_f32 v21, v21, v11
  v_mul_f32 v22, v22, v11
  v_mul_f32 v23, v23, v11
  v_mul_f32 v24, v24, v11
  v_mul_f32 v25, v25, v11
  v_mul_f32 v26, v26, v11
  v_mul_f32 v27, v27, v11
  s_branch L_backd
L_wdma:
  s_cmp_lt_u32 s54, 80
  s_cbranch_scc0 L_fdma
  s_and_b32 s3, s54, 7
  s_lshl_b32 s3, s3, 3
  s_add_u32 s3, s3, s48
  s_mul_i32 s3, s3, 122880
  s_lshr_b32 s66, s54, 3
  s_lshl_b32 s66, s66, 7
  s_add_u32 s3, s3, s66
  s_mul_i32 s65, s48, 12288
  v_lshrrev_b32 v236, 3, v0
  v_mul_u32_u24 v236, 1280, v236
  s_add_u32 s40, s12, s3
  s_addc_u32 s41, s13, 0
  s_mov_b32 s42, 121728
  s_mov_b32 s43, 0x20000
  v_xor_b32 v237, 0, v43
  v_lshl_add_u32 v232, v237, 4, v236
  v_xor_b32 v237, 2, v43
  v_lshl_add_u32 v233, v237, 4, v236
  v_xor_b32 v237, 4, v43
  v_lshl_add_u32 v234, v237, 4, v236
  v_xor_b32 v237, 6, v43
  v_lshl_add_u32 v235, v237, 4, v236
  s_add_u32 m0, s65, 7168
  s_mov_b32 s67, 71680
  buffer_load_dwordx4 v235, s[40:43], s67 offen nt lds
  s_add_u32 m0, s65, 8192
  s_mov_b32 s67, 81920
  buffer_load_dwordx4 v232, s[40:43], s67 offen nt lds
  s_add_u32 m0, s65, 9216
  s_mov_b32 s67, 92160
  buffer_load_dwordx4 v233, s[40:43], s67 offen nt lds
  s_add_u32 m0, s65, 10240
  s_mov_b32 s67, 102400
  buffer_load_dwordx4 v234, s[40:43], s67 offen nt lds
  s_add_u32 m0, s65, 11264
  s_mov_b32 s67, 112640
  buffer_load_dwordx4 v235, s[40:43], s67 offen nt lds
  s_cmp_eq_u32 s48, 7
  s_cbranch_scc1 L_comb
  s_waitcnt vmcnt(5)
  s_branch L_drain2
L_fdma:
  s_sub_u32 s67, s54, 80
  s_lshl_b32 s3, s67, 6
  s_mul_i32 s66, s48, 49152
  s_add_u32 s3, s3, s66
  v_lshrrev_b32 v236, 2, v0
  v_mul_u32_u24 v236, 3072, v236
  v_and_b32 v237, 3, v0
  v_lshrrev_b32 v235, 5, v0
  v_xor_b32 v237, v237, v235
  v_lshl_add_u32 v232, v237, 4, v236
  s_add_u32 s40, s16, s3
  s_addc_u32 s41, s17, 0
  s_mov_b32 s42, 1619008
  s_mov_b32 s43, 0x20000
  s_add_u32 s44, s18, s3
  s_addc_u32 s45, s19, 0
  s_mov_b32 s46, 1619008
  s_mov_b32 s47, 0x20000
  s_sub_u32 s67, s54, 80
  s_lshl_b32 s3, s67, 3
  s_add_u32 s3, s3, s48
  s_mul_i32 s3, s3, 5120
  s_lshl_b32 s65, s48, 10
  s_add_u32 s28, s20, s3
  s_addc_u32 s29, s21, 0
  s_mov_b32 s30, 5120
  s_mov_b32 s31, 0x20000
  s_lshl_b32 s3, s48, 2
  s_and_b32 s3, s3, 8
  v_mul_u32_u24 v236, 1280, v45
  v_and_b32 v237, 15, v0
  v_lshlrev_b32 v235, 1, v45
  v_xor_b32 v237, v237, v235
  v_xor_b32 v237, s3, v237
  v_lshl_add_u32 v233, v237, 4, v236
  s_add_u32 m0, s65, 82176
  s_mov_b32 s67, 0
  buffer_load_dwordx4 v233, s[28:31], s67 offen nt lds
  s_add_u32 m0, s65, 90368
  s_mov_b32 s67, 256
  buffer_load_dwordx4 v233, s[28:31], s67 offen nt lds
  s_add_u32 m0, s65, 98560
  s_mov_b32 s67, 512
  buffer_load_dwordx4 v233, s[28:31], s67 offen nt lds
  s_add_u32 m0, s65, 106752
  s_mov_b32 s67, 768
  buffer_load_dwordx4 v233, s[28:31], s67 offen nt lds
  s_add_u32 m0, s65, 114944
  s_mov_b32 s67, 1024
  buffer_load_dwordx4 v233, s[28:31], s67 offen nt lds
  s_cmp_eq_u32 s48, 7
  s_cbranch_scc1 L_comb
  s_waitcnt vmcnt(5)
  s_branch L_drain2
L_nload:
  v_mov_b32 v12, 0
  v_mov_b32 v13, 0
  v_mov_b32 v14, 0
  v_mov_b32 v15, 0
  v_lshlrev_b32 v9, 4, v0
  v_add_u32 v9, 138240, v9
  ds_write_b128 v9, v[12:15]
  ds_write_b128 v9, v[12:15] offset:512
  v_min_u32 v10, 13, v0
  v_mul_u32_u24 v10, 784, v10
  v_add_u32 v10, 123904, v10
  ds_write_b128 v10, v[12:15]
  v_mov_b32 v13, 28
  ds_write_b64 v41, v[12:13] offset:16
  v_mov_b32 v13, 0
  s_add_u32 s3, s62, 14
  v_mov_b32 v12, s3
  v_mov_b32 v16, -1
  v_mov_b32 v17, -1
  v_mov_b32 v18, -1
  v_mov_b32 v19, -1
  ds_write_b128 v41, v[12:15]
  ds_write_b128 v9, v[16:19] offset:1536
  ds_write_b128 v9, v[16:19] offset:2560
  ds_write_b128 v9, v[16:19] offset:5632
  ds_write_b128 v9, v[16:19] offset:6656
  ds_write_b128 v9, v[16:19] offset:7680
  ds_write_b128 v9, v[16:19] offset:8704
  ds_write_b128 v9, v[16:19] offset:9728
  ds_write_b128 v9, v[16:19] offset:10752
  ds_write_b128 v9, v[16:19] offset:11776
  ds_write_b128 v9, v[16:19] offset:12800
  ds_write_b128 v9, v[16:19] offset:13824
  ds_write_b128 v9, v[16:19] offset:14848
  ds_write_b128 v9, v[16:19] offset:15872
  ds_write_b128 v9, v[16:19] offset:16896
  ds_write_b128 v9, v[16:19] offset:17920
  ds_write_b128 v9, v[16:19] offset:18944
  ds_write_b128 v9, v[16:19] offset:19968
  ds_write_b128 v9, v[16:19] offset:20992
  ds_write_b128 v9, v[16:19] offset:22016
  s_waitcnt lgkmcnt(0)
  s_load_dword s55, s[26:27], 0
  s_mov_b32 s36, s26
  s_mov_b32 s37, s27
  s_mov_b32 s38, 1507328
  s_mov_b32 s39, 0x20000
  s_barrier
  s_cmp_lt_u32 s54, 80
  s_cbranch_scc0 L_noeo
  s_mov_b32 s48, 0
  s_and_b32 s3, s54, 7
  s_lshl_b32 s3, s3, 3
  s_add_u32 s3, s3, s48
  s_mul_i32 s3, s3, 122880
  s_lshr_b32 s66, s54, 3
  s_lshl_b32 s66, s66, 7
  s_add_u32 s3, s3, s66
  s_mul_i32 s65, s48, 12288
  v_lshrrev_b32 v236, 3, v0
  v_mul_u32_u24 v236, 1280, v236
  s_add_u32 s40, s12, s3
  s_addc_u32 s41, s13, 0
  s_mov_b32 s42, 121728
  s_mov_b32 s43, 0x20000
  v_xor_b32 v237, 0, v43
  v_lshl_add_u32 v232, v237, 4, v236
  v_xor_b32 v237, 2, v43
  v_lshl_add_u32 v233, v237, 4, v236
  v_xor_b32 v237, 4, v43
  v_lshl_add_u32 v234, v237, 4, v236
  v_xor_b32 v237, 6, v43
  v_lshl_add_u32 v235, v237, 4, v236
  s_mov_b32 s48, 7
  s_mov_b32 s42, 981888
  s_mov_b32 m0, 0
  s_mov_b32 s66, 0
  buffer_load_dwordx4 v232, s[40:43], s66 offen nt lds
  s_mov_b32 m0, 1024
  s_mov_b32 s66, 10240
  buffer_load_dwordx4 v233, s[40:43], s66 offen nt lds
  s_mov_b32 m0, 2048
  s_mov_b32 s66, 20480
  buffer_load_dwordx4 v234, s[40:43], s66 offen nt lds
  s_mov_b32 m0, 3072
  s_mov_b32 s66, 30720
  buffer_load_dwordx4 v235, s[40:43], s66 offen nt lds
  s_mov_b32 m0, 4096
  s_mov_b32 s66, 40960
  buffer_load_dwordx4 v232, s[40:43], s66 offen nt lds
  s_mov_b32 m0, 5120
  s_mov_b32 s66, 51200
  buffer_load_dwordx4 v233, s[40:43], s66 offen nt lds
  s_mov_b32 m0, 6144
  s_mov_b32 s66, 61440
  buffer_load_dwordx4 v234, s[40:43], s66 offen nt lds
  s_mov_b32 m0, 12288
  s_mov_b32 s66, 122880
  buffer_load_dwordx4 v232, s[40:43], s66 offen nt lds
  s_mov_b32 m0, 13312
  s_mov_b32 s66, 133120
  buffer_load_dwordx4 v233, s[40:43], s66 offen nt lds
  s_mov_b32 m0, 14336
  s_mov_b32 s66, 143360
  buffer_load_dwordx4 v234, s[40:43], s66 offen nt lds
  s_mov_b32 m0, 15360
  s_mov_b32 s66, 153600
  buffer_load_dwordx4 v235, s[40:43], s66 offen nt lds
  s_mov_b32 m0, 16384
  s_mov_b32 s66, 163840
  buffer_load_dwordx4 v232, s[40:43], s66 offen nt lds
  s_mov_b32 m0, 17408
  s_mov_b32 s66, 174080
  buffer_load_dwordx4 v233, s[40:43], s66 offen nt lds
  s_mov_b32 m0, 18432
  s_mov_b32 s66, 184320
  buffer_load_dwordx4 v234, s[40:43], s66 offen nt lds
  s_mov_b32 m0, 24576
  s_mov_b32 s66, 245760
  buffer_load_dwordx4 v232, s[40:43], s66 offen nt lds
  s_mov_b32 m0, 25600
  s_mov_b32 s66, 256000
  buffer_load_dwordx4 v233, s[40:43], s66 offen nt lds
  s_mov_b32 m0, 26624
  s_mov_b32 s66, 266240
  s_waitcnt vmcnt(15)
  buffer_load_dwordx4 v234, s[40:43], s66 offen nt lds
  s_mov_b32 m0, 27648
  s_mov_b32 s66, 276480
  s_waitcnt vmcnt(15)
  buffer_load_dwordx4 v235, s[40:43], s66 offen nt lds
  s_mov_b32 m0, 28672
  s_mov_b32 s66, 286720
  s_waitcnt vmcnt(15)
  buffer_load_dwordx4 v232, s[40:43], s66 offen nt lds
  s_mov_b32 m0, 29696
  s_mov_b32 s66, 296960
  s_waitcnt vmcnt(15)
  buffer_load_dwordx4 v233, s[40:43], s66 offen nt lds
  s_mov_b32 m0, 30720
  s_mov_b32 s66, 307200
  s_waitcnt vmcnt(15)
  buffer_load_dwordx4 v234, s[40:43], s66 offen nt lds
  s_mov_b32 m0, 36864
  s_mov_b32 s66, 368640
  s_waitcnt vmcnt(15)
  buffer_load_dwordx4 v232, s[40:43], s66 offen nt lds
  s_mov_b32 m0, 37888
  s_mov_b32 s66, 378880
  s_waitcnt vmcnt(15)
  buffer_load_dwordx4 v233, s[40:43], s66 offen nt lds
  s_mov_b32 m0, 38912
  s_mov_b32 s66, 389120
  s_waitcnt vmcnt(15)
  buffer_load_dwordx4 v234, s[40:43], s66 offen nt lds
  s_mov_b32 m0, 39936
  s_mov_b32 s66, 399360
  s_waitcnt vmcnt(15)
  buffer_load_dwordx4 v235, s[40:43], s66 offen nt lds
  s_mov_b32 m0, 40960
  s_mov_b32 s66, 409600
  s_waitcnt vmcnt(15)
  buffer_load_dwordx4 v232, s[40:43], s66 offen nt lds
  s_mov_b32 m0, 41984
  s_mov_b32 s66, 419840
  s_waitcnt vmcnt(15)
  buffer_load_dwordx4 v233, s[40:43], s66 offen nt lds
  s_mov_b32 m0, 43008
  s_mov_b32 s66, 430080
  s_waitcnt vmcnt(15)
  buffer_load_dwordx4 v234, s[40:43], s66 offen nt lds
  s_mov_b32 m0, 49152
  s_mov_b32 s66, 491520
  s_waitcnt vmcnt(15)
  buffer_load_dwordx4 v232, s[40:43], s66 offen nt lds
  s_mov_b32 m0, 50176
  s_mov_b32 s66, 501760
  s_waitcnt vmcnt(15)
  buffer_load_dwordx4 v233, s[40:43], s66 offen nt lds
  s_mov_b32 m0, 51200
  s_mov_b32 s66, 512000
  s_waitcnt vmcnt(15)
  buffer_load_dwordx4 v234, s[40:43], s66 offen nt lds
  s_mov_b32 m0, 52224
  s_mov_b32 s66, 522240
  s_waitcnt vmcnt(15)
  buffer_load_dwordx4 v235, s[40:43], s66 offen nt lds
  s_mov_b32 m0, 53248
  s_mov_b32 s66, 532480
  s_waitcnt vmcnt(15)
  buffer_load_dwordx4 v232, s[40:43], s66 offen nt lds
  s_mov_b32 m0, 54272
  s_mov_b32 s66, 542720
  s_waitcnt vmcnt(15)
  buffer_load_dwordx4 v233, s[40:43], s66 offen nt lds
  s_mov_b32 m0, 55296
  s_mov_b32 s66, 552960
  s_waitcnt vmcnt(15)
  buffer_load_dwordx4 v234, s[40:43], s66 offen nt lds
  s_mov_b32 m0, 61440
  s_mov_b32 s66, 614400
  s_waitcnt vmcnt(15)
  buffer_load_dwordx4 v232, s[40:43], s66 offen nt lds
  s_mov_b32 m0, 62464
  s_mov_b32 s66, 624640
  s_waitcnt vmcnt(15)
  buffer_load_dwordx4 v233, s[40:43], s66 offen nt lds
  s_mov_b32 m0, 63488
  s_mov_b32 s66, 634880
  s_waitcnt vmcnt(15)
  buffer_load_dwordx4 v234, s[40:43], s66 offen nt lds
  s_mov_b32 m0, 64512
  s_mov_b32 s66, 645120
  s_waitcnt vmcnt(15)
  buffer_load_dwordx4 v235, s[40:43], s66 offen nt lds
  s_mov_b32 m0, 65536
  s_mov_b32 s66, 655360
  s_waitcnt vmcnt(15)
  buffer_load_dwordx4 v232, s[40:43], s66 offen nt lds
  s_mov_b32 m0, 66560
  s_mov_b32 s66, 665600
  s_waitcnt vmcnt(15)
  buffer_load_dwordx4 v233, s[40:43], s66 offen nt lds
  s_mov_b32 m0, 67584
  s_mov_b32 s66, 675840
  s_waitcnt vmcnt(15)
  buffer_load_dwordx4 v234, s[40:43], s66 offen nt lds
  s_mov_b32 m0, 73728
  s_mov_b32 s66, 737280
  s_waitcnt vmcnt(15)
  buffer_load_dwordx4 v232, s[40:43], s66 offen nt lds
  s_mov_b32 m0, 74752
  s_mov_b32 s66, 747520
  s_waitcnt vmcnt(15)
  buffer_load_dwordx4 v233, s[40:43], s66 offen nt lds
  s_mov_b32 m0, 75776
  s_mov_b32 s66, 757760
  s_waitcnt vmcnt(15)
  buffer_load_dwordx4 v234, s[40:43], s66 offen nt lds
  s_mov_b32 m0, 76800
  s_mov_b32 s66, 768000
  s_waitcnt vmcnt(15)
  buffer_load_dwordx4 v235, s[40:43], s66 offen nt lds
  s_mov_b32 m0, 77824
  s_mov_b32 s66, 778240
  s_waitcnt vmcnt(15)
  buffer_load_dwordx4 v232, s[40:43], s66 offen nt lds
  s_mov_b32 m0, 78848
  s_mov_b32 s66, 788480
  s_waitcnt vmcnt(15)
  buffer_load_dwordx4 v233, s[40:43], s66 offen nt lds
  s_mov_b32 m0, 79872
  s_mov_b32 s66, 798720
  s_waitcnt vmcnt(15)
  buffer_load_dwordx4 v234, s[40:43], s66 offen nt lds
  s_mov_b32 m0, 86016
  s_mov_b32 s66, 860160
  s_waitcnt vmcnt(15)
  buffer_load_dwordx4 v232, s[40:43], s66 offen nt lds
  s_mov_b32 m0, 87040
  s_mov_b32 s66, 870400
  s_waitcnt vmcnt(15)
  buffer_load_dwordx4 v233, s[40:43], s66 offen nt lds
  s_mov_b32 m0, 88064
  s_mov_b32 s66, 880640
  s_waitcnt vmcnt(15)
  buffer_load_dwordx4 v234, s[40:43], s66 offen nt lds
  s_mov_b32 m0, 89088
  s_mov_b32 s66, 890880
  s_waitcnt vmcnt(15)
  buffer_load_dwordx4 v235, s[40:43], s66 offen nt lds
  s_mov_b32 m0, 90112
  s_mov_b32 s66, 901120
  s_waitcnt vmcnt(15)
  buffer_load_dwordx4 v232, s[40:43], s66 offen nt lds
  s_mov_b32 m0, 91136
  s_mov_b32 s66, 911360
  s_waitcnt vmcnt(15)
  buffer_load_dwordx4 v233, s[40:43], s66 offen nt lds
  s_mov_b32 m0, 92160
  s_mov_b32 s66, 921600
  s_waitcnt vmcnt(15)
  buffer_load_dwordx4 v234, s[40:43], s66 offen nt lds
  s_branch L_ldone
L_noeo:
  s_sub_u32 s3, s54, 80
  s_cmp_lt_u32 s3, 48
  s_cbranch_scc0 L_ldone
  s_mov_b32 s48, 0
  s_sub_u32 s67, s54, 80
  s_lshl_b32 s3, s67, 6
  s_mul_i32 s66, s48, 49152
  s_add_u32 s3, s3, s66
  v_lshrrev_b32 v236, 2, v0
  v_mul_u32_u24 v236, 3072, v236
  v_and_b32 v237, 3, v0
  v_lshrrev_b32 v235, 5, v0
  v_xor_b32 v237, v237, v235
  v_lshl_add_u32 v232, v237, 4, v236
  s_add_u32 s40, s16, s3
  s_addc_u32 s41, s17, 0
  s_mov_b32 s42, 1619008
  s_mov_b32 s43, 0x20000
  s_add_u32 s44, s18, s3
  s_addc_u32 s45, s19, 0
  s_mov_b32 s46, 1619008
  s_mov_b32 s47, 0x20000
  s_mov_b32 s48, 7
  s_mov_b32 s42, 1963072
  s_mov_b32 s46, s42
  s_mov_b32 m0, 0
  s_mov_b32 s66, 0
  buffer_load_dwordx4 v232, s[40:43], s66 offen nt lds
  s_mov_b32 m0, 1024
  s_mov_b32 s66, 49152
  buffer_load_dwordx4 v232, s[40:43], s66 offen nt lds
  s_mov_b32 m0, 2048
  s_mov_b32 s66, 98304
  buffer_load_dwordx4 v232, s[40:43], s66 offen nt lds
  s_mov_b32 m0, 3072
  s_mov_b32 s66, 147456
  buffer_load_dwordx4 v232, s[40:43], s66 offen nt lds
  s_mov_b32 m0, 4096
  s_mov_b32 s66, 196608
  buffer_load_dwordx4 v232, s[40:43], s66 offen nt lds
  s_mov_b32 m0, 5120
  s_mov_b32 s66, 245760
  buffer_load_dwordx4 v232, s[40:43], s66 offen nt lds
  s_mov_b32 m0, 6144
  s_mov_b32 s66, 294912
  buffer_load_dwordx4 v232, s[40:43], s66 offen nt lds
  s_mov_b32 m0, 7168
  s_mov_b32 s66, 344064
  buffer_load_dwordx4 v232, s[40:43], s66 offen nt lds
  s_mov_b32 m0, 40992
  s_mov_b32 s66, 0
  buffer_load_dwordx4 v232, s[44:47], s66 offen nt lds
  s_mov_b32 m0, 42016
  s_mov_b32 s66, 49152
  buffer_load_dwordx4 v232, s[44:47], s66 offen nt lds
  s_mov_b32 m0, 43040
  s_mov_b32 s66, 98304
  buffer_load_dwordx4 v232, s[44:47], s66 offen nt lds
  s_mov_b32 m0, 44064
  s_mov_b32 s66, 147456
  buffer_load_dwordx4 v232, s[44:47], s66 offen nt lds
  s_mov_b32 m0, 45088
  s_mov_b32 s66, 196608
  buffer_load_dwordx4 v232, s[44:47], s66 offen nt lds
  s_mov_b32 m0, 46112
  s_mov_b32 s66, 245760
  buffer_load_dwordx4 v232, s[44:47], s66 offen nt lds
  s_mov_b32 m0, 47136
  s_mov_b32 s66, 294912
  buffer_load_dwordx4 v232, s[44:47], s66 offen nt lds
  s_mov_b32 m0, 48160
  s_mov_b32 s66, 344064
  buffer_load_dwordx4 v232, s[44:47], s66 offen nt lds
L_ldone:
  s_waitcnt lgkmcnt(0)
  s_mul_i32 s3, s55, 1664525
  s_add_u32 s3, s3, 1013904223
  s_or_b32 s3, s3, 0x01010101
  s_xor_b32 s55, s55, s3
  s_and_b32 s56, s55, 0xff
  s_bfe_u32 s57, s55, 0x80008
  s_bfe_u32 s58, s55, 0x80010
  s_lshr_b32 s59, s55, 24
  s_load_dwordx2 s[44:45], s[0:1], 80
  s_cmp_lt_u32 s54, 128
  s_cbranch_scc1 L_voted
  s_sub_u32 s3, s54, 128
  s_mul_i32 s3, s3, 2
  s_and_b32 s66, s3, 63
  s_lshr_b32 s3, s3, 6
  s_lshl_b32 s3, s3, 7
  s_add_u32 s3, s3, s66
  s_bfe_u32 s67, s54, 0x10003
  s_lshl_b32 s66, s67, 6
  s_add_u32 s3, s3, s66
  s_lshl_b32 s3, s3, 7
  s_add_u32 s65, s3, 851968
  s_xor_b32 s66, s65, 8192
  s_lshr_b32 s3, s52, 1
  s_xor_b32 s67, s67, s3
  s_mov_b32 s68, 0
  s_memtime s[28:29]
  s_waitcnt lgkmcnt(0)
  s_load_dword s3, s[26:27], s65
  s_waitcnt lgkmcnt(0)
  s_memtime s[30:31]
  s_waitcnt lgkmcnt(0)
  s_load_dword s3, s[26:27], s66
  s_waitcnt lgkmcnt(0)
  s_memtime s[32:33]
  s_add_u32 s65, s65, 128
  s_add_u32 s66, s66, 128
  s_waitcnt lgkmcnt(0)
  s_sub_u32 s28, s30, s28
  s_sub_u32 s32, s32, s30
  s_sub_i32 s3, s28, s32
  s_min_i32 s3, s3, 1024
  s_max_i32 s3, s3, -1024
  s_add_i32 s68, s68, s3
  s_memtime s[28:29]
  s_waitcnt lgkmcnt(0)
  s_load_dword s3, s[26:27], s65
  s_waitcnt lgkmcnt(0)
  s_memtime s[30:31]
  s_waitcnt lgkmcnt(0)
  s_load_dword s3, s[26:27], s66
  s_waitcnt lgkmcnt(0)
  s_memtime s[32:33]
  s_add_u32 s65, s65, 128
  s_add_u32 s66, s66, 128
  s_waitcnt lgkmcnt(0)
  s_sub_u32 s28, s30, s28
  s_sub_u32 s32, s32, s30
  s_sub_i32 s3, s28, s32
  s_min_i32 s3, s3, 1024
  s_max_i32 s3, s3, -1024
  s_add_i32 s68, s68, s3
  s_sub_i32 s3, 0, s68
  s_cmp_eq_u32 s67, 0
  s_cselect_b32 s3, s68, s3
  s_add_i32 s3, s3, 16779264
  v_mov_b32 v12, s3
  v_mov_b32 v13, 0
  s_mov_b64 exec, 1
  global_atomic_add v13, v12, s[44:45] sc1
  s_mov_b64 exec, -1
L_voted:
  s_mov_b64 exec, -1
L_qw_h:
  ds_read_b32 v10, v41 offset:4
  s_waitcnt lgkmcnt(0)
  v_cmp_ne_u32 vcc, 1, v10
  s_cbranch_vccnz L_qw_h
  s_mov_b32 s66, s64
  v_mov_b32 v40, 0
  v_mov_b32 v13, 512
  s_cmp_lt_u32 s54, 128
  s_cselect_b32 s68, 0, 4
  s_add_u32 s65, s62, 12
  v_lshlrev_b32 v11, 2, v0
  v_add_u32 v11, 139776, v11
  v_mov_b32 v12, v13
  s_cmp_eq_u32 s68, 0
  s_cbranch_scc1 L_khend
L_kh:
  ds_read_b32 v10, v41 offset:20
  s_waitcnt lgkmcnt(0)
  v_readfirstlane_b32 s3, v10
  s_add_u32 s3, s3, s65
  s_cmp_lt_u32 s3, s66
  s_cbranch_scc1 L_kh
  v_mov_b32 v42, 8
  s_mov_b64 exec, 1
  buffer_atomic_add v42, v40, s[36:39], s53 offen offset:4 sc0 sc1
  s_mov_b64 exec, -1
  s_sub_u32 s60, s66, s64
  v_add_u32 v11, s60, v0
  v_lshlrev_b32 v11, 2, v11
  v_add_u32 v11, 139776, v11
  v_mov_b32 v12, v13
  v_cmp_gt_u32 vcc, 8, v0
  s_waitcnt vmcnt(0)
  v_readfirstlane_b32 s3, v42
  s_cmp_ge_u32 s3, 424
  s_cbranch_scc1 L_khend
  s_add_u32 s66, s66, 8
  v_add_u32 v12, s3, v0
  v_or_b32 v14, 0x8000, v12
  s_add_u32 s3, s3, 8
  s_cmp_ge_u32 s3, 424
  s_cselect_b32 s68, 1, s68
  s_mov_b64 exec, vcc
  ds_write_b32 v11, v12 offset:20480
  ds_write_b32 v11, v14
  s_mov_b64 exec, -1
  s_sub_u32 s68, s68, 1
  s_cmp_lg_u32 s68, 0
  s_cbranch_scc1 L_kh
  v_cndmask_b32 v12, v13, v12, vcc
L_khend:
  ds_write_b32 v11, v12 offset:20480
L_vwait:
  ds_read_b32 v10, v41 offset:20
  s_waitcnt lgkmcnt(0)
  v_readfirstlane_b32 s3, v10
  s_add_u32 s3, s3, s65
  s_cmp_lt_u32 s3, s64
  s_cbranch_scc1 L_vwait
  s_mov_b32 s61, 0
L_tally:
  s_load_dword s3, s[44:45], 0 glc
  s_add_u32 s61, s61, 1
  s_cmp_ge_u32 s61, 200000
  s_waitcnt lgkmcnt(0)
  s_cbranch_scc1 L_tallied
  s_cmp_lt_u32 s3, 0x80000000
  s_cbranch_scc1 L_tally
L_tallied:
  s_cmp_gt_u32 s3, 0x80040000
  s_cselect_b32 s24, 8192, 0
  v_mov_b32 v12, s24
  ds_write_b32 v41, v12 offset:12
L_sgc:
  s_mov_b32 s67, 22
  v_mov_b32 v40, 0
  v_mov_b32 v13, 512
  s_movk_i32 s68, 512
  s_cmp_lt_u32 s54, 128
  s_cselect_b32 s68, 500, s68
  s_cmp_lt_u32 s54, 80
  s_cselect_b32 s68, 504, s68
  s_cmp_lt_u32 s54, 128
  s_cselect_b32 s69, s68, 0
  s_sub_u32 s69, s69, 1
  s_movk_i32 s68, 512
  v_mov_b32 v12, 0
  s_mov_b32 s65, 12
L_help:

  ds_read_b32 v10, v41
  s_waitcnt lgkmcnt(0)
  v_readfirstlane_b32 s3, v10
  s_add_u32 s3, s3, s65
  s_cmp_lt_u32 s3, s66
  s_cbranch_scc1 L_help
  s_mov_b32 s65, 4
  s_load_dword s3, s[26:27], s53 glc
  s_sub_u32 s60, s66, s64
  v_add_u32 v11, s60, v0
  v_lshlrev_b32 v11, 2, v11
  v_add_u32 v11, 139776, v11
  s_mov_b64 vcc, 0
  s_waitcnt lgkmcnt(0)
  s_cmp_gt_u32 s3, s69
  s_cbranch_scc1 L_helpend
  s_sub_i32 s3, s68, s3
  s_ashr_i32 s3, s3, 2
  s_max_i32 s67, s3, 7
  s_min_u32 s67, s67, 56
  v_mov_b32 v42, s67
  s_mov_b64 exec, 1
  buffer_atomic_add v42, v40, s[36:39], s53 offen sc0 sc1
  s_mov_b64 exec, -1
  s_sub_u32 s3, s66, s64
  v_add_u32 v11, s3, v0
  v_lshlrev_b32 v11, 2, v11
  s_add_u32 s66, s66, s67
  v_add_u32 v11, 139776, v11
  s_waitcnt vmcnt(0)
  v_readfirstlane_b32 s3, v42
  s_nop 1
  v_add_u32 v12, s3, v0
  s_add_u32 s3, s3, s67
  v_cmp_gt_u32 vcc, s67, v0
  s_cmp_ge_u32 s3, s68
  s_cbranch_scc1 L_helpend
  s_sub_u32 s3, s68, s3
  s_lshr_b32 s3, s3, 2
  s_mov_b64 exec, vcc
  ds_write_b32 v11, v12
  s_mov_b64 exec, -1
  s_max_u32 s67, s3, 7
  s_min_u32 s67, s67, 56
  s_branch L_help
L_helpend:
  s_sub_u32 s3, s67, 0
  v_cndmask_b32 v12, v13, v12, vcc
  v_cmp_le_u32 vcc, s3, v0
  v_or_b32 v13, 0x400, v12
  s_nop 0
  v_cndmask_b32 v12, v12, v13, vcc
  ds_write_b32 v11, v12
  s_cmp_lt_u32 s54, 128
  s_cbranch_scc1 L_wdma
L_comb:
  v_lshlrev_b32 v9, 4, v0
  v_add_u32 v10, 123136, v9
  v_mov_b32 v11, 123904
  v_mov_b32 v47, 0xffffff00
  s_and_b32 s3, s49, 15
  s_lshl_b32 s3, s3, 1
  s_lshr_b32 s66, s49, 4
  s_add_u32 s3, s3, s66
  s_lshl_b32 s3, s3, 1
  s_add_u32 s3, s3, s51
  s_lshl_b32 s3, s3, 2
  s_add_u32 s3, s3, s52
  s_lshl_b32 s3, s3, 10
  s_xor_b32 s3, s3, s24
  s_add_u32 s66, s3, 131072
  v_cmp_eq_u32 s[68:69], 48, v0
  s_mov_b32 exec_lo, 0xffffffff
  s_mov_b32 exec_hi, 0x1ffff
L_cc0:
  ds_read_b128 v[16:19], v11 offset:0
  ds_read_b128 v[48:51], v10 offset:0
  ds_read_b128 v[52:55], v10 offset:784
L_cw0:
  s_waitcnt lgkmcnt(2)
  v_cmp_ne_u32 vcc, 1, v19
  s_cbranch_vccnz L_cc0
  ds_read_b128 v[20:23], v11 offset:1568
  ds_read_b128 v[56:59], v10 offset:1568
  ds_read_b128 v[60:63], v10 offset:2352
  v_mov_b32 v32, v16
  v_mov_b32 v33, v17
  s_waitcnt lgkmcnt(3)
  v_pk_add_f32 v[12:13], v[48:49], v[52:53]
  v_pk_add_f32 v[14:15], v[50:51], v[54:55]
  s_branch L_cw1
L_cc1:
  ds_read_b128 v[20:23], v11 offset:1568
  ds_read_b128 v[56:59], v10 offset:1568
  ds_read_b128 v[60:63], v10 offset:2352
L_cw1:
  s_waitcnt lgkmcnt(2)
  v_cmp_ne_u32 vcc, 1, v23
  s_cbranch_vccnz L_cc1
  ds_read_b128 v[16:19], v11 offset:3136
  ds_read_b128 v[48:51], v10 offset:3136
  ds_read_b128 v[52:55], v10 offset:3920
  v_min_f32 v34, v33, v21
  v_max_f32 v32, v32, v20
  v_sub_f32 v24, v34, v33
  v_sub_f32 v26, v34, v21
  v_exp_f32 v24, v24
  v_exp_f32 v26, v26
  v_mov_b32 v33, v34
  s_waitcnt lgkmcnt(3)
  v_pk_add_f32 v[56:57], v[56:57], v[60:61]
  v_pk_add_f32 v[58:59], v[58:59], v[62:63]
  v_pk_mul_f32 v[12:13], v[12:13], v[24:25] op_sel_hi:[1,0]
  v_pk_mul_f32 v[14:15], v[14:15], v[24:25] op_sel_hi:[1,0]
  v_pk_fma_f32 v[12:13], v[56:57], v[26:27], v[12:13] op_sel_hi:[1,0,1]
  v_pk_fma_f32 v[14:15], v[58:59], v[26:27], v[14:15] op_sel_hi:[1,0,1]
  s_branch L_cw2
L_cc2:
  ds_read_b128 v[16:19], v11 offset:3136
  ds_read_b128 v[48:51], v10 offset:3136
  ds_read_b128 v[52:55], v10 offset:3920
L_cw2:
  s_waitcnt lgkmcnt(2)
  v_cmp_ne_u32 vcc, 1, v19
  s_cbranch_vccnz L_cc2
  ds_read_b128 v[20:23], v11 offset:4704
  ds_read_b128 v[56:59], v10 offset:4704
  ds_read_b128 v[60:63], v10 offset:5488
  v_min_f32 v34, v33, v17
  v_max_f32 v32, v32, v16
  v_sub_f32 v24, v34, v33
  v_sub_f32 v26, v34, v17
  v_exp_f32 v24, v24
  v_exp_f32 v26, v26
  v_mov_b32 v33, v34
  s_waitcnt lgkmcnt(3)
  v_pk_add_f32 v[48:49], v[48:49], v[52:53]
  v_pk_add_f32 v[50:51], v[50:51], v[54:55]
  v_pk_mul_f32 v[12:13], v[12:13], v[24:25] op_sel_hi:[1,0]
  v_pk_mul_f32 v[14:15], v[14:15], v[24:25] op_sel_hi:[1,0]
  v_pk_fma_f32 v[12:13], v[48:49], v[26:27], v[12:13] op_sel_hi:[1,0,1]
  v_pk_fma_f32 v[14:15], v[50:51], v[26:27], v[14:15] op_sel_hi:[1,0,1]
  s_branch L_cw3
L_cc3:
  ds_read_b128 v[20:23], v11 offset:4704
  ds_read_b128 v[56:59], v10 offset:4704
  ds_read_b128 v[60:63], v10 offset:5488
L_cw3:
  s_waitcnt lgkmcnt(2)
  v_cmp_ne_u32 vcc, 1, v23
  s_cbranch_vccnz L_cc3
  ds_read_b128 v[16:19], v11 offset:6272
  ds_read_b128 v[48:51], v10 offset:6272
  ds_read_b128 v[52:55], v10 offset:7056
  v_min_f32 v34, v33, v21
  v_max_f32 v32, v32, v20
  v_sub_f32 v24, v34, v33
  v_sub_f32 v26, v34, v21
  v_exp_f32 v24, v24
  v_exp_f32 v26, v26
  v_mov_b32 v33, v34
  s_waitcnt lgkmcnt(3)
  v_pk_add_f32 v[56:57], v[56:57], v[60:61]
  v_pk_add_f32 v[58:59], v[58:59], v[62:63]
  v_pk_mul_f32 v[12:13], v[12:13], v[24:25] op_sel_hi:[1,0]
  v_pk_mul_f32 v[14:15], v[14:15], v[24:25] op_sel_hi:[1,0]
  v_pk_fma_f32 v[12:13], v[56:57], v[26:27], v[12:13] op_sel_hi:[1,0,1]
  v_pk_fma_f32 v[14:15], v[58:59], v[26:27], v[14:15] op_sel_hi:[1,0,1]
  s_branch L_cw4
L_cc4:
  ds_read_b128 v[16:19], v11 offset:6272
  ds_read_b128 v[48:51], v10 offset:6272
  ds_read_b128 v[52:55], v10 offset:7056
L_cw4:
  s_waitcnt lgkmcnt(2)
  v_cmp_ne_u32 vcc, 1, v19
  s_cbranch_vccnz L_cc4
  ds_read_b128 v[20:23], v11 offset:7840
  ds_read_b128 v[56:59], v10 offset:7840
  ds_read_b128 v[60:63], v10 offset:8624
  v_min_f32 v34, v33, v17
  v_max_f32 v32, v32, v16
  v_sub_f32 v24, v34, v33
  v_sub_f32 v26, v34, v17
  v_exp_f32 v24, v24
  v_exp_f32 v26, v26
  v_mov_b32 v33, v34
  s_waitcnt lgkmcnt(3)
  v_pk_add_f32 v[48:49], v[48:49], v[52:53]
  v_pk_add_f32 v[50:51], v[50:51], v[54:55]
  v_pk_mul_f32 v[12:13], v[12:13], v[24:25] op_sel_hi:[1,0]
  v_pk_mul_f32 v[14:15], v[14:15], v[24:25] op_sel_hi:[1,0]
  v_pk_fma_f32 v[12:13], v[48:49], v[26:27], v[12:13] op_sel_hi:[1,0,1]
  v_pk_fma_f32 v[14:15], v[50:51], v[26:27], v[14:15] op_sel_hi:[1,0,1]
  s_branch L_cw5
L_cc5:
  ds_read_b128 v[20:23], v11 offset:7840
  ds_read_b128 v[56:59], v10 offset:7840
  ds_read_b128 v[60:63], v10 offset:8624
L_cw5:
  s_waitcnt lgkmcnt(2)
  v_cmp_ne_u32 vcc, 1, v23
  s_cbranch_vccnz L_cc5
  ds_read_b128 v[16:19], v11 offset:9408
  ds_read_b128 v[48:51], v10 offset:9408
  ds_read_b128 v[52:55], v10 offset:10192
  v_min_f32 v34, v33, v21
  v_max_f32 v32, v32, v20
  v_sub_f32 v24, v34, v33
  v_sub_f32 v26, v34, v21
  v_exp_f32 v24, v24
  v_exp_f32 v26, v26
  v_mov_b32 v33, v34
  s_waitcnt lgkmcnt(3)
  v_pk_add_f32 v[56:57], v[56:57], v[60:61]
  v_pk_add_f32 v[58:59], v[58:59], v[62:63]
  v_pk_mul_f32 v[12:13], v[12:13], v[24:25] op_sel_hi:[1,0]
  v_pk_mul_f32 v[14:15], v[14:15], v[24:25] op_sel_hi:[1,0]
  v_pk_fma_f32 v[12:13], v[56:57], v[26:27], v[12:13] op_sel_hi:[1,0,1]
  v_pk_fma_f32 v[14:15], v[58:59], v[26:27], v[14:15] op_sel_hi:[1,0,1]
  s_branch L_cw6
L_cc6:
  ds_read_b128 v[16:19], v11 offset:9408
  ds_read_b128 v[48:51], v10 offset:9408
  ds_read_b128 v[52:55], v10 offset:10192
L_cw6:
  s_waitcnt lgkmcnt(2)
  v_cmp_ne_u32 vcc, 1, v19
  s_cbranch_vccnz L_cc6
  v_min_f32 v34, v33, v17
  v_max_f32 v32, v32, v16
  v_sub_f32 v24, v34, v33
  v_sub_f32 v26, v34, v17
  v_exp_f32 v24, v24
  v_exp_f32 v26, v26
  v_mov_b32 v33, v34
  s_waitcnt lgkmcnt(0)
  v_pk_add_f32 v[48:49], v[48:49], v[52:53]
  v_pk_add_f32 v[50:51], v[50:51], v[54:55]
  v_pk_mul_f32 v[12:13], v[12:13], v[24:25] op_sel_hi:[1,0]
  v_pk_mul_f32 v[14:15], v[14:15], v[24:25] op_sel_hi:[1,0]
  v_pk_fma_f32 v[12:13], v[48:49], v[26:27], v[12:13] op_sel_hi:[1,0,1]
  v_pk_fma_f32 v[14:15], v[50:51], v[26:27], v[14:15] op_sel_hi:[1,0,1]
  v_cndmask_b32 v12, v12, v32, s[68:69]
  v_and_or_b32 v12, v12, v47, s56
  v_and_or_b32 v13, v13, v47, s57
  v_and_or_b32 v14, v14, v47, s58
  v_and_or_b32 v15, v15, v47, s59
  buffer_store_dwordx4 v[12:15], v9, s[36:39], s66 offen sc1
  s_mov_b64 exec, -1
  s_cmp_lt_u32 s54, 80
  s_cbranch_scc1 L_orole
  s_cmp_lt_u32 s54, 128
  s_cbranch_scc1 L_frole
  s_branch L_nhelp
L_orole:
  s_barrier
  s_and_b32 s3, s54, 7
  s_and_b32 s66, s3, 3
  s_lshl_b32 s66, s66, 2
  s_lshr_b32 s67, s48, 1
  s_add_u32 s66, s66, s67
  s_lshl_b32 s66, s66, 1
  s_lshr_b32 s67, s3, 2
  s_add_u32 s66, s66, s67
  s_lshl_b32 s66, s66, 1
  s_and_b32 s67, s48, 1
  s_add_u32 s66, s66, s67
  s_lshl_b32 s66, s66, 12
  s_xor_b32 s66, s66, s24
  s_add_u32 s66, s66, 131072
  s_lshl_b32 s3, s3, 14
  s_lshr_b32 s67, s54, 3
  s_lshl_b32 s67, s67, 2
  s_add_u32 s67, s67, s48
  s_lshl_b32 s67, s67, 7
  s_add_u32 s67, s67, s3
  s_add_u32 s67, s67, 393216
  v_lshlrev_b32 v9, 4, v0

  s_mov_b32 exec_lo, 0xffffffff
  s_mov_b32 exec_hi, 0x1ffff
  buffer_load_dwordx4 v[48:51], v9, s[36:39], s66 offen offset:0 sc1
  buffer_load_dwordx4 v[52:55], v9, s[36:39], s66 offen offset:1024 sc1
  buffer_load_dwordx4 v[56:59], v9, s[36:39], s66 offen offset:2048 sc1
  buffer_load_dwordx4 v[60:63], v9, s[36:39], s66 offen offset:3072 sc1
  s_mov_b64 exec, -1
  s_and_b32 s3, s48, 1
  s_mul_i32 s3, s3, 1664
  s_add_u32 s3, s3, 134656
  s_lshr_b32 s65, s48, 1
  s_mul_i32 s65, s65, 12
  v_lshrrev_b32 v41, 3, v0
  v_bfe_u32 v42, v0, 1, 1
  v_lshl_add_u32 v41, v41, 1, v42
  v_add_u32 v41, s65, v41
  v_lshrrev_b32 v40, 4, v41
  v_and_b32 v42, 3, v41
  v_lshl_add_u32 v40, v40, 2, v42
  v_bfe_u32 v42, v41, 2, 2
  v_lshl_add_u32 v40, v40, 2, v42
  v_lshlrev_b32 v40, 5, v40
  v_and_b32 v41, 1, v0
  v_lshl_add_u32 v40, v41, 3, v40
  v_and_b32 v41, 4, v0
  v_add3_u32 v40, v40, v41, s3
  v_and_b32 v42, 1, v0
  v_mul_u32_u24 v41, 1664, v42
  v_bfe_u32 v42, v0, 1, 3
  v_lshl_add_u32 v41, v42, 4, v41
  v_lshl_add_u32 v41, v45, 7, v41
  v_add_u32 v41, 134656, v41
  v_bfe_u32 v42, v0, 1, 1
  v_mul_u32_u24 v34, 0xaaaa, v42
  v_add_u32 v34, 0x4444, v34
  v_and_b32 v42, 31, v0
  v_lshrrev_b32 v46, 5, v0
  v_lshlrev_b32 v46, 13, v46
  v_lshl_add_u32 v42, v42, 2, v46
  v_lshlrev_b32 v35, 3, v0
  v_bfe_u32 v35, s55, v35, 8
  v_mov_b32 v64, 0
  v_mov_b32 v65, 0
  v_mov_b32 v66, 0
  v_mov_b32 v67, 0
  v_mov_b32 v68, 0
  v_mov_b32 v69, 0
  v_mov_b32 v70, 0
  v_mov_b32 v71, 0
  v_mov_b32 v72, 0
  v_mov_b32 v73, 0
  v_mov_b32 v74, 0
  v_mov_b32 v75, 0
  v_mov_b32 v76, 0
  v_mov_b32 v77, 0
  v_mov_b32 v78, 0
  v_mov_b32 v79, 0
  v_mov_b32 v47, 0xffffff00
  v_bfe_u32 v12, v0, 2, 2
  v_lshl_add_u32 v10, v12, 3, v45
  v_lshlrev_b32 v10, 7, v10
  v_xor_b32 v12, s48, v12
  v_lshl_add_u32 v10, v12, 5, v10
  v_and_b32 v12, 3, v0
  v_lshl_add_u32 v10, v12, 3, v10
  v_add_u32 v11, 49152, v10
  s_cmp_lt_u32 s48, 4
  s_cbranch_scc0 L_o_notr0
  ds_read_b64_tr_b16 v[128:129], v10 offset:0
  ds_read_b64_tr_b16 v[130:131], v10 offset:512
  ds_read_b64_tr_b16 v[140:141], v10 offset:12288
  ds_read_b64_tr_b16 v[142:143], v10 offset:12800
  ds_read_b64_tr_b16 v[152:153], v10 offset:24576
  ds_read_b64_tr_b16 v[154:155], v10 offset:25088
  ds_read_b64_tr_b16 v[164:165], v10 offset:36864
  ds_read_b64_tr_b16 v[166:167], v10 offset:37376
  ds_read_b64_tr_b16 v[176:177], v11 offset:0
  ds_read_b64_tr_b16 v[178:179], v11 offset:512
  ds_read_b64_tr_b16 v[188:189], v11 offset:12288
  ds_read_b64_tr_b16 v[190:191], v11 offset:12800
  ds_read_b64_tr_b16 v[200:201], v11 offset:24576
  ds_read_b64_tr_b16 v[202:203], v11 offset:25088
  ds_read_b64_tr_b16 v[212:213], v11 offset:36864
  ds_read_b64_tr_b16 v[214:215], v11 offset:37376
L_o_notr0:
  s_waitcnt vmcnt(8)
  s_barrier
  s_cbranch_scc0 L_o_notr1
  ds_read_b64_tr_b16 v[132:133], v10 offset:4096
  ds_read_b64_tr_b16 v[134:135], v10 offset:4608
  ds_read_b64_tr_b16 v[144:145], v10 offset:16384
  ds_read_b64_tr_b16 v[146:147], v10 offset:16896
  ds_read_b64_tr_b16 v[156:157], v10 offset:28672
  ds_read_b64_tr_b16 v[158:159], v10 offset:29184
  ds_read_b64_tr_b16 v[168:169], v10 offset:40960
  ds_read_b64_tr_b16 v[170:171], v10 offset:41472
  ds_read_b64_tr_b16 v[180:181], v11 offset:4096
  ds_read_b64_tr_b16 v[182:183], v11 offset:4608
  ds_read_b64_tr_b16 v[192:193], v11 offset:16384
  ds_read_b64_tr_b16 v[194:195], v11 offset:16896
  ds_read_b64_tr_b16 v[204:205], v11 offset:28672
  ds_read_b64_tr_b16 v[206:207], v11 offset:29184
  ds_read_b64_tr_b16 v[216:217], v11 offset:40960
  ds_read_b64_tr_b16 v[218:219], v11 offset:41472
L_o_notr1:
  s_waitcnt vmcnt(4)
  s_barrier
  s_cbranch_scc0 L_o_notr2
  ds_read_b64_tr_b16 v[136:137], v10 offset:8192
  ds_read_b64_tr_b16 v[138:139], v10 offset:8704
  ds_read_b64_tr_b16 v[148:149], v10 offset:20480
  ds_read_b64_tr_b16 v[150:151], v10 offset:20992
  ds_read_b64_tr_b16 v[160:161], v10 offset:32768
  ds_read_b64_tr_b16 v[162:163], v10 offset:33280
  ds_read_b64_tr_b16 v[172:173], v10 offset:45056
  ds_read_b64_tr_b16 v[174:175], v10 offset:45568
  ds_read_b64_tr_b16 v[184:185], v11 offset:8192
  ds_read_b64_tr_b16 v[186:187], v11 offset:8704
  ds_read_b64_tr_b16 v[196:197], v11 offset:20480
  ds_read_b64_tr_b16 v[198:199], v11 offset:20992
  ds_read_b64_tr_b16 v[208:209], v11 offset:32768
  ds_read_b64_tr_b16 v[210:211], v11 offset:33280
  ds_read_b64_tr_b16 v[220:221], v11 offset:45056
  ds_read_b64_tr_b16 v[222:223], v11 offset:45568
L_o_notr2:
  s_mov_b32 exec_lo, 0xffffffff
  s_mov_b32 exec_hi, 0x1ffff
  s_mov_b32 s64, 0
  s_mov_b32 s61, 0
  v_mov_b32 v11, 0
  s_branch L_og_i3
L_og_poll:
  s_bitcmp1_b32 s64, 0
  s_cbranch_scc1 L_og_i0
  buffer_load_dwordx4 v[48:51], v9, s[36:39], s66 offen offset:0 sc1
L_og_i0:
  s_bitcmp1_b32 s64, 1
  s_cbranch_scc1 L_og_i1
  buffer_load_dwordx4 v[52:55], v9, s[36:39], s66 offen offset:1024 sc1
L_og_i1:
  s_bitcmp1_b32 s64, 2
  s_cbranch_scc1 L_og_i2
  buffer_load_dwordx4 v[56:59], v9, s[36:39], s66 offen offset:2048 sc1
L_og_i2:
  s_bitcmp1_b32 s64, 3
  s_cbranch_scc1 L_og_i3
  buffer_load_dwordx4 v[60:63], v9, s[36:39], s66 offen offset:3072 sc1
L_og_i3:
  s_bitcmp1_b32 s64, 0
  s_cbranch_scc1 L_og_c0
  s_waitcnt vmcnt(0)
  v_xor_b32 v48, s56, v48
  v_xor_b32 v49, s57, v49
  v_xor_b32 v50, s58, v50
  v_xor_b32 v51, s59, v51
  v_or3_b32 v10, v48, v49, v50
  v_or_b32 v10, v10, v51
  v_cmp_ne_u32_sdwa vcc, v10, v11 src0_sel:BYTE_0 src1_sel:DWORD
  s_cbranch_vccnz L_og_c0
  s_bitset1_b32 s64, 0
  s_cmp_eq_u32 s64, 15
  s_cbranch_scc1 L_og_done
L_og_c0:
  s_bitcmp1_b32 s64, 1
  s_cbranch_scc1 L_og_c1
  s_waitcnt vmcnt(0)
  v_xor_b32 v52, s56, v52
  v_xor_b32 v53, s57, v53
  v_xor_b32 v54, s58, v54
  v_xor_b32 v55, s59, v55
  v_or3_b32 v10, v52, v53, v54
  v_or_b32 v10, v10, v55
  v_cmp_ne_u32_sdwa vcc, v10, v11 src0_sel:BYTE_0 src1_sel:DWORD
  s_cbranch_vccnz L_og_c1
  s_bitset1_b32 s64, 1
  s_cmp_eq_u32 s64, 15
  s_cbranch_scc1 L_og_done
L_og_c1:
  s_bitcmp1_b32 s64, 2
  s_cbranch_scc1 L_og_c2
  s_waitcnt vmcnt(0)
  v_xor_b32 v56, s56, v56
  v_xor_b32 v57, s57, v57
  v_xor_b32 v58, s58, v58
  v_xor_b32 v59, s59, v59
  v_or3_b32 v10, v56, v57, v58
  v_or_b32 v10, v10, v59
  v_cmp_ne_u32_sdwa vcc, v10, v11 src0_sel:BYTE_0 src1_sel:DWORD
  s_cbranch_vccnz L_og_c2
  s_bitset1_b32 s64, 2
  s_cmp_eq_u32 s64, 15
  s_cbranch_scc1 L_og_done
L_og_c2:
  s_bitcmp1_b32 s64, 3
  s_cbranch_scc1 L_og_c3
  s_waitcnt vmcnt(0)
  v_xor_b32 v60, s56, v60
  v_xor_b32 v61, s57, v61
  v_xor_b32 v62, s58, v62
  v_xor_b32 v63, s59, v63
  v_or3_b32 v10, v60, v61, v62
  v_or_b32 v10, v10, v63
  v_cmp_ne_u32_sdwa vcc, v10, v11 src0_sel:BYTE_0 src1_sel:DWORD
  s_cbranch_vccnz L_og_c3
  s_bitset1_b32 s64, 3
  s_cmp_eq_u32 s64, 15
  s_cbranch_scc1 L_og_done
L_og_c3:
  s_add_u32 s61, s61, 1
  s_cmp_lt_u32 s61, 200000
  s_cbranch_scc1 L_og_poll
L_og_done:
  v_max3_f32 v16, v48, v52, v56
  v_max_f32 v16, v16, v60
  v_mul_f32 v16, s63, v16
  v_fma_f32 v17, v48, s63, -v16
  v_fma_f32 v18, v52, s63, -v16
  v_fma_f32 v19, v56, s63, -v16
  v_fma_f32 v20, v60, s63, -v16
  v_exp_f32 v17, v17
  v_exp_f32 v18, v18
  v_exp_f32 v19, v19
  v_exp_f32 v20, v20
  v_mul_f32 v16, v17, v50
  v_readlane_b32 s4, v17, 48
  v_fma_f32 v16, v18, v54, v16
  v_readlane_b32 s6, v18, 48
  v_fma_f32 v16, v19, v58, v16
  v_readlane_b32 s8, v19, 48
  v_fma_f32 v16, v20, v62, v16
  v_readlane_b32 s10, v20, 48
  v_rcp_f32 v16, v16
  v_pk_mul_f32 v[12:13], v[48:49], s[4:5] op_sel_hi:[1,0]
  v_pk_mul_f32 v[14:15], v[50:51], s[4:5] op_sel_hi:[1,0]
  v_readlane_b32 s12, v16, 48
  v_pk_fma_f32 v[12:13], v[52:53], s[6:7], v[12:13] op_sel_hi:[1,0,1]
  v_pk_fma_f32 v[14:15], v[54:55], s[6:7], v[14:15] op_sel_hi:[1,0,1]
  v_pk_fma_f32 v[12:13], v[56:57], s[8:9], v[12:13] op_sel_hi:[1,0,1]
  v_pk_fma_f32 v[14:15], v[58:59], s[8:9], v[14:15] op_sel_hi:[1,0,1]
  v_pk_fma_f32 v[12:13], v[60:61], s[10:11], v[12:13] op_sel_hi:[1,0,1]
  v_pk_fma_f32 v[14:15], v[62:63], s[10:11], v[14:15] op_sel_hi:[1,0,1]
  v_pk_mul_f32 v[12:13], v[12:13], s[12:13] op_sel_hi:[1,0]
  v_pk_mul_f32 v[14:15], v[14:15], s[12:13] op_sel_hi:[1,0]
  v_cvt_pk_bf16_f32 v12, v12, v13
  v_cvt_pk_bf16_f32 v13, v14, v15
  s_mov_b32 exec_lo, 0xffffffff
  s_mov_b32 exec_hi, 0xffff
  ds_write2_b32 v40, v12, v13 offset1:4
  s_mov_b64 exec, -1
  s_waitcnt lgkmcnt(0)
  s_barrier
  s_cmp_lt_u32 s48, 4
  s_cbranch_scc0 L_fin
  ds_read_b128 v[48:51], v41 offset:0
  ds_read_b128 v[52:55], v41 offset:512
  ds_read_b128 v[56:59], v41 offset:1024
  s_waitcnt lgkmcnt(2)
  v_smfmac_f32_16x16x64_bf16 v[64:67], v[48:51], v[128:135], v34
  s_waitcnt lgkmcnt(1)
  v_smfmac_f32_16x16x64_bf16 v[64:67], v[52:55], v[160:167], v34
  s_waitcnt lgkmcnt(0)
  v_smfmac_f32_16x16x64_bf16 v[64:67], v[56:59], v[192:199], v34
  v_smfmac_f32_16x16x64_bf16 v[68:71], v[48:51], v[136:143], v34
  v_smfmac_f32_16x16x64_bf16 v[68:71], v[52:55], v[168:175], v34
  v_smfmac_f32_16x16x64_bf16 v[68:71], v[56:59], v[200:207], v34
  v_smfmac_f32_16x16x64_bf16 v[72:75], v[48:51], v[144:151], v34
  v_smfmac_f32_16x16x64_bf16 v[72:75], v[52:55], v[176:183], v34
  v_smfmac_f32_16x16x64_bf16 v[72:75], v[56:59], v[208:215], v34
  v_smfmac_f32_16x16x64_bf16 v[76:79], v[48:51], v[152:159], v34
  v_smfmac_f32_16x16x64_bf16 v[76:79], v[52:55], v[184:191], v34
  v_add_f32_dpp v16, v64, v66 quad_perm:[0,1,2,3] row_mask:0x1 bank_mask:0xf
  v_add_f32_dpp v17, v65, v67 quad_perm:[0,1,2,3] row_mask:0x1 bank_mask:0xf
  v_smfmac_f32_16x16x64_bf16 v[76:79], v[56:59], v[216:223], v34
  v_add_f32_dpp v16, v68, v70 quad_perm:[0,1,2,3] row_mask:0x2 bank_mask:0xf
  v_add_f32_dpp v17, v69, v71 quad_perm:[0,1,2,3] row_mask:0x2 bank_mask:0xf
  s_nop 0
  v_add_f32_dpp v16, v72, v74 quad_perm:[0,1,2,3] row_mask:0x4 bank_mask:0xf
  v_add_f32_dpp v17, v73, v75 quad_perm:[0,1,2,3] row_mask:0x4 bank_mask:0xf
  s_nop 2
  v_add_f32_dpp v16, v76, v78 quad_perm:[0,1,2,3] row_mask:0x8 bank_mask:0xf
  v_add_f32_dpp v17, v77, v79 quad_perm:[0,1,2,3] row_mask:0x8 bank_mask:0xf
  s_nop 1
  v_permlane16_swap_b32 v16, v17
  v_add_f32 v18, v16, v17
  v_add_f32 v16, v16, v17
  s_nop 1
  v_permlane32_swap_b32 v16, v18
  v_add_f32 v16, v16, v18
  v_and_or_b32 v16, v16, v47, v35
  buffer_store_dword v16, v42, s[36:39], s67 offen sc1
  s_lshr_b32 s3, s54, 1
  s_lshl_b32 s3, s3, 13
  s_and_b32 s4, s54, 1
  s_lshl_b32 s4, s4, 2
  s_add_u32 s4, s4, s48
  s_mul_i32 s4, s4, 768
  s_add_u32 s3, s3, s4
  s_add_u32 s3, s3, 524288
  v_lshlrev_b32 v20, 7, v0
  s_mov_b64 exec, 63
  buffer_load_dword v21, v20, s[36:39], s3 offen sc1
  s_branch L_fin
L_frole:
  s_barrier
  s_sub_u32 s67, s54, 80
  s_lshl_b32 s3, s67, 6
  s_mul_i32 s66, s48, 49152
  s_add_u32 s3, s3, s66
  v_lshrrev_b32 v236, 2, v0
  v_mul_u32_u24 v236, 3072, v236
  v_and_b32 v237, 3, v0
  v_lshrrev_b32 v235, 5, v0
  v_xor_b32 v237, v237, v235
  v_lshl_add_u32 v232, v237, 4, v236
  s_add_u32 s40, s16, s3
  s_addc_u32 s41, s17, 0
  s_mov_b32 s42, 1619008
  s_mov_b32 s43, 0x20000
  s_add_u32 s44, s18, s3
  s_addc_u32 s45, s19, 0
  s_mov_b32 s46, 1619008
  s_mov_b32 s47, 0x20000
  s_sub_u32 s67, s54, 80
  s_lshl_b32 s3, s67, 3
  s_add_u32 s3, s3, s48
  s_mul_i32 s3, s3, 5120
  s_lshl_b32 s65, s48, 10
  s_add_u32 s28, s20, s3
  s_addc_u32 s29, s21, 0
  s_mov_b32 s30, 5120
  s_mov_b32 s31, 0x20000
  s_lshl_b32 s3, s48, 2
  s_and_b32 s3, s3, 8
  v_mul_u32_u24 v236, 1280, v45
  v_and_b32 v237, 15, v0
  v_lshlrev_b32 v235, 1, v45
  v_xor_b32 v237, v237, v235
  v_xor_b32 v237, s3, v237
  v_lshl_add_u32 v233, v237, 4, v236
  s_add_u32 m0, s65, 8192
  s_mov_b32 s67, 393216
  buffer_load_dwordx4 v232, s[40:43], s67 offen nt lds
  s_add_u32 m0, s65, 49184
  s_mov_b32 s67, 393216
  buffer_load_dwordx4 v232, s[44:47], s67 offen nt lds
  s_add_u32 m0, s65, 16384
  s_mov_b32 s67, 786432
  buffer_load_dwordx4 v232, s[40:43], s67 offen nt lds
  s_add_u32 m0, s65, 57376
  s_mov_b32 s67, 786432
  buffer_load_dwordx4 v232, s[44:47], s67 offen nt lds
  s_add_u32 m0, s65, 24576
  s_mov_b32 s67, 1179648
  buffer_load_dwordx4 v232, s[40:43], s67 offen nt lds
  s_add_u32 m0, s65, 65568
  s_mov_b32 s67, 1179648
  buffer_load_dwordx4 v232, s[44:47], s67 offen nt lds
  s_add_u32 m0, s65, 32768
  s_mov_b32 s67, 1572864
  buffer_load_dwordx4 v232, s[40:43], s67 offen nt lds
  s_add_u32 m0, s65, 73760
  s_mov_b32 s67, 1572864
  buffer_load_dwordx4 v232, s[44:47], s67 offen nt lds
  s_mov_b32 s32, s4
  s_mov_b32 s33, s5
  s_mov_b32 s34, 2560
  s_mov_b32 s35, 0x20000
  v_mov_b32 v47, 0xffffff00
  s_sub_u32 s54, s54, 80
  v_lshrrev_b32 v9, 3, v0
  v_and_b32 v11, 3, v0
  v_lshlrev_b32 v9, 5, v9
  v_lshl_add_u32 v9, v11, 3, v9
  s_max_u32 s69, s48, 3
  s_sub_u32 s69, s69, 3
  s_lshl_b32 s3, s69, 8
  v_add_u32 v9, s3, v9
  v_bfe_u32 v46, v0, 2, 1
  v_mul_u32_u24 v10, 1280, v46
  v_add_u32 v38, v9, v10
  buffer_load_dwordx2 v[36:37], v38, s[32:35], 0 offen
  v_lshrrev_b32 v9, 5, v9
  v_lshrrev_b32 v39, 4, v9
  v_and_b32 v10, 3, v9
  v_lshl_add_u32 v39, v39, 2, v10
  v_bfe_u32 v10, v9, 2, 2
  v_lshl_add_u32 v39, v39, 2, v10
  v_lshlrev_b32 v39, 5, v39
  v_mul_u32_u24 v10, 1664, v46
  v_lshl_add_u32 v10, v11, 2, v10
  v_add_u32 v39, v39, v10
  v_add_u32 v39, 134656, v39
  v_bfe_u32 v9, v0, 2, 2
  v_lshl_add_u32 v10, v45, 3, v9
  v_lshlrev_b32 v12, 8, v10
  v_and_b32 v13, 1, v45
  v_lshl_add_u32 v14, v13, 2, v9
  v_xor_b32 v14, s48, v14
  v_lshl_add_u32 v12, v14, 5, v12
  v_lshl_add_u32 v12, v11, 3, v12
  v_add_u32 v32, 82176, v12
  v_mov_b32 v18, v10
  v_mov_b32 v19, v13
  v_lshlrev_b32 v9, 4, v0
  s_lshr_b32 s12, s52, 1
  s_lshl_b32 s12, s12, 13
  s_xor_b32 s12, s12, s24
  s_lshl_b32 s3, s69, 10
  s_add_u32 s3, s3, s12
  s_add_u32 s4, s3, 393216
  s_add_u32 s5, s4, 16384
  s_add_u32 s6, s5, 16384
  s_add_u32 s7, s6, 16384
  s_add_u32 s8, s7, 16384
  s_add_u32 s9, s8, 16384
  s_add_u32 s10, s9, 16384
  s_add_u32 s11, s10, 16384
  v_bfe_u32 v10, v0, 4, 1
  v_lshlrev_b32 v40, 6, v46
  v_lshl_add_u32 v40, v10, 2, v40
  s_lshl_b32 s3, s69, 3
  s_add_u32 s3, s3, 137984
  v_add_u32 v40, s3, v40
  v_lshlrev_b32 v34, 6, v10
  v_add_u32 v41, 137984, v34
  v_lshl_add_u32 v34, v43, 1, v34
  s_lshl_b32 s3, s48, 4
  s_add_u32 s3, s3, 139136
  v_add_u32 v34, s3, v34
  v_cmp_eq_u32 vcc, 0, v44
  v_mov_b32 v25, s63
  s_nop 0
  v_cndmask_b32 v25, 1.0, v25, vcc
  s_mov_b32 s20, 0x3acccccd
  v_and_b32 v10, 1, v0
  v_mul_u32_u24 v42, 1664, v10
  v_bfe_u32 v10, v0, 1, 3
  v_lshl_add_u32 v42, v10, 4, v42
  v_lshl_add_u32 v42, v45, 7, v42
  v_add_u32 v42, 134656, v42
  v_bfe_u32 v10, v0, 1, 1
  v_mul_u32_u24 v24, 0xaaaa, v10
  v_add_u32 v24, 0x4444, v24
  v_mov_b32 v60, 0
  v_mov_b32 v61, 0
  v_mov_b32 v62, 0
  v_mov_b32 v63, 0
  v_mov_b32 v64, 0
  v_mov_b32 v65, 0
  v_mov_b32 v66, 0
  v_mov_b32 v67, 0
  v_mov_b32 v68, 0
  v_mov_b32 v69, 0
  v_mov_b32 v70, 0
  v_mov_b32 v71, 0
  v_mov_b32 v72, 0
  v_mov_b32 v73, 0
  v_mov_b32 v74, 0
  v_mov_b32 v75, 0
  v_mov_b32 v228, 0
  v_mov_b32 v229, 0
  v_mov_b32 v230, 0
  v_mov_b32 v231, 0
  v_and_b32 v35, 1, v0
  v_lshlrev_b32 v35, 6, v35
  v_lshl_add_u32 v35, v45, 4, v35
  v_bfe_u32 v10, v0, 1, 3
  v_lshl_add_u32 v33, v10, 3, s48
  v_cmp_lt_u32 vcc, 19, v33
  v_lshlrev_b32 v33, 14, v33
  v_subrev_u32 v12, 319488, v33
  v_cndmask_b32 v33, v33, v12, vcc
  v_xor_b32 v33, s24, v33
  v_add_u32 v33, v33, v35
  v_lshlrev_b32 v10, 7, v10
  v_sub_u32 v35, v35, v10
  v_add_u32 v35, 139136, v35
  s_lshl_b32 s13, s54, 7
  s_add_u32 s13, s13, 524288
  s_lshl_b32 s3, s52, 1
  s_add_u32 s3, s3, s50
  s_sub_u32 s14, s54, s3
  s_and_b32 s3, s3, 4
  s_mul_i32 s3, s3, 5
  s_sub_u32 s15, s14, s3
  s_lshl_b32 s15, s15, 14
  s_add_u32 s15, s15, s12
  s_mov_b32 s68, 0x3f803f80
  v_mov_b32 v16, 0
  v_mov_b32 v17, 0
  v_lshlrev_b32 v18, 6, v18
  v_xor_b32 v13, s48, v19
  v_lshl_add_u32 v18, v13, 4, v18
  v_and_b32 v13, 1, v0
  v_lshl_add_u32 v18, v13, 3, v18
  v_bfe_u32 v13, v0, 1, 1
  v_mul_u32_u24 v13, 40992, v13
  v_add_u32 v18, v18, v13
  v_mov_b32 v20, 0x3f803f80
  v_mov_b32 v21, v20
  v_mov_b32 v22, v20
  v_mov_b32 v23, v20
  s_cmp_lt_u32 s48, 4
  s_waitcnt vmcnt(1)
  s_barrier
  s_cmp_lt_u32 s48, 3
  s_cbranch_scc1 L_f_nog
  buffer_load_dwordx4 v[88:91], v9, s[36:39], s4 offen offset:0 sc1
  buffer_load_dwordx4 v[92:95], v9, s[36:39], s5 offen offset:0 sc1
  buffer_load_dwordx4 v[96:99], v9, s[36:39], s6 offen offset:0 sc1
  buffer_load_dwordx4 v[100:103], v9, s[36:39], s7 offen offset:0 sc1
  buffer_load_dwordx4 v[104:107], v9, s[36:39], s8 offen offset:0 sc1
  buffer_load_dwordx4 v[108:111], v9, s[36:39], s9 offen offset:0 sc1
  buffer_load_dwordx4 v[112:115], v9, s[36:39], s10 offen offset:0 sc1
  buffer_load_dwordx4 v[116:119], v9, s[36:39], s11 offen offset:0 sc1
  s_cmp_lt_u32 s48, 4
L_f_nog:
  ds_read_b64_tr_b16 v[208:209], v32 offset:0
  ds_read_b64_tr_b16 v[210:211], v32 offset:1024
  ds_read_b64_tr_b16 v[212:213], v32 offset:8192
  ds_read_b64_tr_b16 v[214:215], v32 offset:9216
  ds_read_b64_tr_b16 v[216:217], v32 offset:16384
  ds_read_b64_tr_b16 v[218:219], v32 offset:17408
  ds_read_b64_tr_b16 v[220:221], v32 offset:24576
  ds_read_b64_tr_b16 v[222:223], v32 offset:25600
  ds_read_b64_tr_b16 v[224:225], v32 offset:32768
  ds_read_b64_tr_b16 v[226:227], v32 offset:33792
  s_cbranch_scc0 L_f_notr5
  ds_read_b64_tr_b16 v[128:129], v18 offset:0
  ds_read_b64_tr_b16 v[130:131], v18 offset:256
  ds_read_b64_tr_b16 v[132:133], v18 offset:2048
  ds_read_b64_tr_b16 v[134:135], v18 offset:2304
  ds_read_b64_tr_b16 v[136:137], v18 offset:4096
  ds_read_b64_tr_b16 v[138:139], v18 offset:4352
  ds_read_b64_tr_b16 v[140:141], v18 offset:6144
  ds_read_b64_tr_b16 v[142:143], v18 offset:6400
  ds_read_b64_tr_b16 v[144:145], v18 offset:8192
  ds_read_b64_tr_b16 v[146:147], v18 offset:8448
  ds_read_b64_tr_b16 v[148:149], v18 offset:10240
  ds_read_b64_tr_b16 v[150:151], v18 offset:10496
  ds_read_b64_tr_b16 v[152:153], v18 offset:12288
  ds_read_b64_tr_b16 v[154:155], v18 offset:12544
  ds_read_b64_tr_b16 v[156:157], v18 offset:14336
  ds_read_b64_tr_b16 v[158:159], v18 offset:14592
  ds_read_b64_tr_b16 v[160:161], v18 offset:16384
  ds_read_b64_tr_b16 v[162:163], v18 offset:16640
  ds_read_b64_tr_b16 v[164:165], v18 offset:18432
  ds_read_b64_tr_b16 v[166:167], v18 offset:18688
  ds_read_b64_tr_b16 v[168:169], v18 offset:20480
  ds_read_b64_tr_b16 v[170:171], v18 offset:20736
  ds_read_b64_tr_b16 v[172:173], v18 offset:22528
  ds_read_b64_tr_b16 v[174:175], v18 offset:22784
  ds_read_b64_tr_b16 v[176:177], v18 offset:24576
  ds_read_b64_tr_b16 v[178:179], v18 offset:24832
  ds_read_b64_tr_b16 v[180:181], v18 offset:26624
  ds_read_b64_tr_b16 v[182:183], v18 offset:26880
  ds_read_b64_tr_b16 v[184:185], v18 offset:28672
  ds_read_b64_tr_b16 v[186:187], v18 offset:28928
  ds_read_b64_tr_b16 v[188:189], v18 offset:30720
  ds_read_b64_tr_b16 v[190:191], v18 offset:30976
  ds_read_b64_tr_b16 v[192:193], v18 offset:32768
  ds_read_b64_tr_b16 v[194:195], v18 offset:33024
  ds_read_b64_tr_b16 v[196:197], v18 offset:34816
  ds_read_b64_tr_b16 v[198:199], v18 offset:35072
  ds_read_b64_tr_b16 v[200:201], v18 offset:36864
  ds_read_b64_tr_b16 v[202:203], v18 offset:37120
  ds_read_b64_tr_b16 v[204:205], v18 offset:38912
  ds_read_b64_tr_b16 v[206:207], v18 offset:39168
  s_waitcnt lgkmcnt(0)
  v_smfmac_f32_16x16x64_bf16 v[228:231], v[20:23], v[128:135], v24
  v_smfmac_f32_16x16x64_bf16 v[228:231], v[20:23], v[136:143], v24
  v_smfmac_f32_16x16x64_bf16 v[228:231], v[20:23], v[144:151], v24
  v_smfmac_f32_16x16x64_bf16 v[228:231], v[20:23], v[152:159], v24
  v_smfmac_f32_16x16x64_bf16 v[228:231], v[20:23], v[160:167], v24
  v_smfmac_f32_16x16x64_bf16 v[228:231], v[20:23], v[168:175], v24
  v_smfmac_f32_16x16x64_bf16 v[228:231], v[20:23], v[176:183], v24
  v_smfmac_f32_16x16x64_bf16 v[228:231], v[20:23], v[184:191], v24
  v_smfmac_f32_16x16x64_bf16 v[228:231], v[20:23], v[192:199], v24
  v_smfmac_f32_16x16x64_bf16 v[228:231], v[20:23], v[200:207], v24
  s_nop 7
  v_add_f32 v228, v228, v230
L_f_notr5:
  s_cmp_lt_u32 s48, 3
  s_cbranch_scc1 L_f_stat
  s_waitcnt vmcnt(8)
  v_lshlrev_b32 v12, 16, v36
  v_and_b32 v13, 0xffff0000, v36
  v_lshlrev_b32 v14, 16, v37
  v_and_b32 v15, 0xffff0000, v37
  s_mov_b32 s64, 255
  s_mov_b32 s61, 0
  s_mov_b32 s65, 0
  v_mov_b32 v11, 0
  s_waitcnt vmcnt(7)
  v_xor_b32 v88, s56, v88
  v_xor_b32 v89, s57, v89
  v_xor_b32 v90, s58, v90
  v_xor_b32 v91, s59, v91
  v_or3_b32 v10, v88, v89, v90
  v_or_b32 v10, v10, v91
  v_cmp_ne_u32_sdwa vcc, v10, v11 src0_sel:BYTE_0 src1_sel:DWORD
  s_cbranch_vccnz L_fg_f0
  v_pk_add_f32 v[12:13], v[12:13], v[88:89]
  v_pk_add_f32 v[14:15], v[14:15], v[90:91]
  s_bitset0_b32 s64, 0
L_fg_f0:
  s_waitcnt vmcnt(6)
  v_xor_b32 v92, s56, v92
  v_xor_b32 v93, s57, v93
  v_xor_b32 v94, s58, v94
  v_xor_b32 v95, s59, v95
  v_or3_b32 v10, v92, v93, v94
  v_or_b32 v10, v10, v95
  v_cmp_ne_u32_sdwa vcc, v10, v11 src0_sel:BYTE_0 src1_sel:DWORD
  s_cbranch_vccnz L_fg_f1
  v_pk_add_f32 v[12:13], v[12:13], v[92:93]
  v_pk_add_f32 v[14:15], v[14:15], v[94:95]
  s_bitset0_b32 s64, 1
L_fg_f1:
  s_waitcnt vmcnt(5)
  v_xor_b32 v96, s56, v96
  v_xor_b32 v97, s57, v97
  v_xor_b32 v98, s58, v98
  v_xor_b32 v99, s59, v99
  v_or3_b32 v10, v96, v97, v98
  v_or_b32 v10, v10, v99
  v_cmp_ne_u32_sdwa vcc, v10, v11 src0_sel:BYTE_0 src1_sel:DWORD
  s_cbranch_vccnz L_fg_f2
  v_pk_add_f32 v[12:13], v[12:13], v[96:97]
  v_pk_add_f32 v[14:15], v[14:15], v[98:99]
  s_bitset0_b32 s64, 2
L_fg_f2:
  s_waitcnt vmcnt(4)
  v_xor_b32 v100, s56, v100
  v_xor_b32 v101, s57, v101
  v_xor_b32 v102, s58, v102
  v_xor_b32 v103, s59, v103
  v_or3_b32 v10, v100, v101, v102
  v_or_b32 v10, v10, v103
  v_cmp_ne_u32_sdwa vcc, v10, v11 src0_sel:BYTE_0 src1_sel:DWORD
  s_cbranch_vccnz L_fg_f3
  v_pk_add_f32 v[12:13], v[12:13], v[100:101]
  v_pk_add_f32 v[14:15], v[14:15], v[102:103]
  s_bitset0_b32 s64, 3
L_fg_f3:
  s_waitcnt vmcnt(3)
  v_xor_b32 v104, s56, v104
  v_xor_b32 v105, s57, v105
  v_xor_b32 v106, s58, v106
  v_xor_b32 v107, s59, v107
  v_or3_b32 v10, v104, v105, v106
  v_or_b32 v10, v10, v107
  v_cmp_ne_u32_sdwa vcc, v10, v11 src0_sel:BYTE_0 src1_sel:DWORD
  s_cbranch_vccnz L_fg_f4
  v_pk_add_f32 v[12:13], v[12:13], v[104:105]
  v_pk_add_f32 v[14:15], v[14:15], v[106:107]
  s_bitset0_b32 s64, 4
L_fg_f4:
  s_waitcnt vmcnt(2)
  v_xor_b32 v108, s56, v108
  v_xor_b32 v109, s57, v109
  v_xor_b32 v110, s58, v110
  v_xor_b32 v111, s59, v111
  v_or3_b32 v10, v108, v109, v110
  v_or_b32 v10, v10, v111
  v_cmp_ne_u32_sdwa vcc, v10, v11 src0_sel:BYTE_0 src1_sel:DWORD
  s_cbranch_vccnz L_fg_f5
  v_pk_add_f32 v[12:13], v[12:13], v[108:109]
  v_pk_add_f32 v[14:15], v[14:15], v[110:111]
  s_bitset0_b32 s64, 5
L_fg_f5:
  s_waitcnt vmcnt(1)
  v_xor_b32 v112, s56, v112
  v_xor_b32 v113, s57, v113
  v_xor_b32 v114, s58, v114
  v_xor_b32 v115, s59, v115
  v_or3_b32 v10, v112, v113, v114
  v_or_b32 v10, v10, v115
  v_cmp_ne_u32_sdwa vcc, v10, v11 src0_sel:BYTE_0 src1_sel:DWORD
  s_cbranch_vccnz L_fg_f6
  v_pk_add_f32 v[12:13], v[12:13], v[112:113]
  v_pk_add_f32 v[14:15], v[14:15], v[114:115]
  s_bitset0_b32 s64, 6
L_fg_f6:
  s_waitcnt vmcnt(0)
  v_xor_b32 v116, s56, v116
  v_xor_b32 v117, s57, v117
  v_xor_b32 v118, s58, v118
  v_xor_b32 v119, s59, v119
  v_or3_b32 v10, v116, v117, v118
  v_or_b32 v10, v10, v119
  v_cmp_ne_u32_sdwa vcc, v10, v11 src0_sel:BYTE_0 src1_sel:DWORD
  s_cbranch_vccnz L_fg_f7
  v_pk_add_f32 v[12:13], v[12:13], v[116:117]
  v_pk_add_f32 v[14:15], v[14:15], v[118:119]
  s_bitset0_b32 s64, 7
L_fg_f7:
  s_cmp_eq_u32 s64, 0
  s_cbranch_scc1 L_fg_done
  s_and_b32 s65, s65, s64
  s_cselect_b32 s65, s65, s64
  s_ff1_i32_b32 s16, s65
  s_bitset0_b32 s65, s16
  s_lshl_b32 s3, s16, 14
  s_add_u32 s3, s3, s4
  buffer_load_dwordx4 v[88:91], v9, s[36:39], s3 offen sc1
  s_and_b32 s65, s65, s64
  s_cselect_b32 s65, s65, s64
  s_ff1_i32_b32 s17, s65
  s_bitset0_b32 s65, s17
  s_lshl_b32 s3, s17, 14
  s_add_u32 s3, s3, s4
  buffer_load_dwordx4 v[92:95], v9, s[36:39], s3 offen sc1
L_fg_rot:
  s_and_b32 s65, s65, s64
  s_cselect_b32 s65, s65, s64
  s_ff1_i32_b32 s18, s65
  s_bitset0_b32 s65, s18
  s_lshl_b32 s3, s18, 14
  s_add_u32 s3, s3, s4
  buffer_load_dwordx4 v[96:99], v9, s[36:39], s3 offen sc1
  s_waitcnt vmcnt(2)
  v_xor_b32 v88, s56, v88
  v_xor_b32 v89, s57, v89
  v_xor_b32 v90, s58, v90
  v_xor_b32 v91, s59, v91
  v_or3_b32 v10, v88, v89, v90
  v_or_b32 v10, v10, v91
  v_cmp_ne_u32_sdwa vcc, v10, v11 src0_sel:BYTE_0 src1_sel:DWORD
  s_cbranch_vccz L_fg_v0
L_fg_b0:
  s_and_b32 s65, s65, s64
  s_cselect_b32 s65, s65, s64
  s_ff1_i32_b32 s16, s65
  s_bitset0_b32 s65, s16
  s_lshl_b32 s3, s16, 14
  s_add_u32 s3, s3, s4
  buffer_load_dwordx4 v[88:91], v9, s[36:39], s3 offen sc1
  s_waitcnt vmcnt(2)
  v_xor_b32 v92, s56, v92
  v_xor_b32 v93, s57, v93
  v_xor_b32 v94, s58, v94
  v_xor_b32 v95, s59, v95
  v_or3_b32 v10, v92, v93, v94
  v_or_b32 v10, v10, v95
  v_cmp_ne_u32_sdwa vcc, v10, v11 src0_sel:BYTE_0 src1_sel:DWORD
  s_cbranch_vccz L_fg_v1
L_fg_b1:
  s_and_b32 s65, s65, s64
  s_cselect_b32 s65, s65, s64
  s_ff1_i32_b32 s17, s65
  s_bitset0_b32 s65, s17
  s_lshl_b32 s3, s17, 14
  s_add_u32 s3, s3, s4
  buffer_load_dwordx4 v[92:95], v9, s[36:39], s3 offen sc1
  s_waitcnt vmcnt(2)
  v_xor_b32 v96, s56, v96
  v_xor_b32 v97, s57, v97
  v_xor_b32 v98, s58, v98
  v_xor_b32 v99, s59, v99
  v_or3_b32 v10, v96, v97, v98
  v_or_b32 v10, v10, v99
  v_cmp_ne_u32_sdwa vcc, v10, v11 src0_sel:BYTE_0 src1_sel:DWORD
  s_cbranch_vccz L_fg_v2
L_fg_b2:
  s_add_u32 s61, s61, 1
  s_cmp_lt_u32 s61, 200000
  s_cbranch_scc1 L_fg_rot
  s_branch L_fg_done
L_fg_v0:
  s_bitcmp1_b32 s64, s16
  s_cbranch_scc0 L_fg_b0
  v_pk_add_f32 v[12:13], v[12:13], v[88:89]
  v_pk_add_f32 v[14:15], v[14:15], v[90:91]
  s_bitset0_b32 s64, s16
  s_cmp_lg_u32 s64, 0
  s_cbranch_scc1 L_fg_b0
  s_branch L_fg_done
L_fg_v1:
  s_bitcmp1_b32 s64, s17
  s_cbranch_scc0 L_fg_b1
  v_pk_add_f32 v[12:13], v[12:13], v[92:93]
  v_pk_add_f32 v[14:15], v[14:15], v[94:95]
  s_bitset0_b32 s64, s17
  s_cmp_lg_u32 s64, 0
  s_cbranch_scc1 L_fg_b1
  s_branch L_fg_done
L_fg_v2:
  s_bitcmp1_b32 s64, s18
  s_cbranch_scc0 L_fg_b2
  v_pk_add_f32 v[12:13], v[12:13], v[96:97]
  v_pk_add_f32 v[14:15], v[14:15], v[98:99]
  s_bitset0_b32 s64, s18
  s_cmp_lg_u32 s64, 0
  s_cbranch_scc1 L_fg_b2
L_fg_done:
  v_cvt_pk_bf16_f32 v12, v12, v13
  v_cvt_pk_bf16_f32 v13, v14, v15
  v_dot2_f32_bf16 v16, v12, s68, 0
  v_dot2_f32_bf16 v17, v12, v12, 0
  ds_write2_b32 v39, v12, v13 offset1:4
  v_dot2_f32_bf16 v16, v13, s68, v16
  v_dot2_f32_bf16 v17, v13, v13, v17
  s_nop 2
  v_permlane16_swap_b32 v16, v17
  v_add_f32 v16, v16, v17
  v_mov_b32 v17, v16
  s_nop 1
  v_permlane32_swap_b32 v16, v17
  v_add_f32 v16, v16, v17
  s_nop 1
  v_add_f32_dpp v16, v16, v16 quad_perm:[1,0,3,2] row_mask:0xf bank_mask:0xf
  s_nop 1
  v_add_f32_dpp v16, v16, v16 quad_perm:[2,3,0,1] row_mask:0xf bank_mask:0xf
  s_nop 1
  v_add_f32_dpp v16, v16, v16 row_ror:8 row_mask:0xf bank_mask:0xf
  s_mov_b64 exec, 0x00110011
  ds_write_b32 v40, v16
  s_mov_b64 exec, -1
L_f_stat:
  s_cmp_lt_u32 s48, 4
  s_waitcnt lgkmcnt(0)
  s_barrier
  s_cbranch_scc0 L_f_act
  ds_read_b128 v[48:51], v42
  ds_read_b128 v[76:79], v41
  ds_read_b128 v[80:83], v41 offset:16
  ds_read_b64 v[84:85], v41 offset:32
  ds_read_b128 v[52:55], v42 offset:512
  ds_read_b128 v[56:59], v42 offset:1024
  s_waitcnt lgkmcnt(5)
  v_smfmac_f32_16x16x64_bf16 v[60:63], v[48:51], v[128:135], v24
  v_smfmac_f32_16x16x64_bf16 v[64:67], v[48:51], v[136:143], v24
  s_waitcnt lgkmcnt(2)
  v_pk_add_f32 v[76:77], v[76:77], v[78:79]
  v_pk_add_f32 v[80:81], v[80:81], v[82:83]
  v_smfmac_f32_16x16x64_bf16 v[68:71], v[48:51], v[144:151], v24
  v_pk_add_f32 v[76:77], v[76:77], v[84:85]
  v_pk_add_f32 v[76:77], v[76:77], v[80:81]
  v_smfmac_f32_16x16x64_bf16 v[72:75], v[48:51], v[152:159], v24
  v_pk_mul_f32 v[76:77], v[76:77], s[20:21] op_sel_hi:[1,0]
  v_fma_f32 v77, -v76, v76, v77
  s_waitcnt lgkmcnt(1)
  v_smfmac_f32_16x16x64_bf16 v[68:71], v[52:55], v[176:183], v24
  v_max_f32 v77, 0, v77
  v_cvt_pk_bf16_f32 v78, -v76, v77
  v_smfmac_f32_16x16x64_bf16 v[72:75], v[52:55], v[184:191], v24
  v_and_b32 v77, 0xffff0000, v78
  v_add_f32 v77, 0x3727c5ac, v77
  v_smfmac_f32_16x16x64_bf16 v[60:63], v[52:55], v[160:167], v24
  v_cvt_pk_bf16_f32 v77, v77, v77
  v_lshlrev_b32 v77, 16, v77
  s_waitcnt lgkmcnt(0)
  v_smfmac_f32_16x16x64_bf16 v[60:63], v[56:59], v[192:199], v24
  v_sqrt_f32 v77, v77
  v_lshlrev_b32 v76, 16, v78
  v_smfmac_f32_16x16x64_bf16 v[64:67], v[52:55], v[168:175], v24
  v_cvt_pk_bf16_f32 v77, v77, v77
  v_lshlrev_b32 v77, 16, v77
  v_smfmac_f32_16x16x64_bf16 v[64:67], v[56:59], v[200:207], v24
  v_rcp_f32 v77, v77
  v_add_f32_dpp v16, v68, v70 quad_perm:[0,1,2,3] row_mask:0x4 bank_mask:0xf
  v_mul_f32 v228, v228, v76
  v_add_f32_dpp v17, v69, v71 quad_perm:[0,1,2,3] row_mask:0x4 bank_mask:0xf
  v_mul_f32 v77, v25, v77
  v_add_f32_dpp v16, v72, v74 quad_perm:[0,1,2,3] row_mask:0x8 bank_mask:0xf
  v_mul_f32 v228, v228, v77
  v_add_f32_dpp v17, v73, v75 quad_perm:[0,1,2,3] row_mask:0x8 bank_mask:0xf
  v_add_f32_dpp v16, v60, v62 quad_perm:[0,1,2,3] row_mask:0x1 bank_mask:0xf
  s_nop 0
  v_add_f32_dpp v17, v61, v63 quad_perm:[0,1,2,3] row_mask:0x1 bank_mask:0xf
  v_add_f32_dpp v16, v64, v66 quad_perm:[0,1,2,3] row_mask:0x2 bank_mask:0xf
  s_nop 0
  v_add_f32_dpp v17, v65, v67 quad_perm:[0,1,2,3] row_mask:0x2 bank_mask:0xf
  s_nop 1
  v_permlane16_swap_b32 v16, v17
  v_add_f32 v18, v16, v17
  v_add_f32 v16, v16, v17
  s_nop 1
  v_permlane32_swap_b32 v16, v18
  v_add_f32 v16, v16, v18
  v_fma_f32 v16, v16, v77, v228
  v_exp_f32 v17, -v16
  s_nop 0
  v_add_f32 v17, 1.0, v17
  v_rcp_f32 v17, v17
  s_nop 1
  v_mul_f32_dpp v16, v16, v17 row_shl:8 row_mask:0xf bank_mask:0xf
  s_mov_b64 exec, 0xff00ff
  v_cvt_pk_bf16_f32 v12, v16, v16
  ds_write_b16 v34, v12
  s_mov_b64 exec, -1
  s_waitcnt lgkmcnt(0)
L_f_act:
  s_barrier
  ds_read_b128 v[48:51], v35 offset:0
  ds_read_b128 v[52:55], v35 offset:128
  ds_read_b128 v[56:59], v35 offset:256
  ds_read_b128 v[60:63], v35 offset:384
  ds_read_b128 v[64:67], v35 offset:512
  s_waitcnt lgkmcnt(4)
  v_mfma_f32_16x16x32_bf16 v[16:19], v[208:211], v[48:51], 0
  s_waitcnt lgkmcnt(3)
  v_mfma_f32_16x16x32_bf16 v[16:19], v[212:215], v[52:55], v[16:19]
  s_waitcnt lgkmcnt(2)
  v_mfma_f32_16x16x32_bf16 v[16:19], v[216:219], v[56:59], v[16:19]
  s_waitcnt lgkmcnt(1)
  v_mfma_f32_16x16x32_bf16 v[16:19], v[220:223], v[60:63], v[16:19]
  s_waitcnt lgkmcnt(0)
  v_mfma_f32_16x16x32_bf16 v[16:19], v[224:227], v[64:67], v[16:19]
  s_nop 7
  v_and_or_b32 v16, v16, v47, s56
  v_and_or_b32 v17, v17, v47, s57
  v_and_or_b32 v18, v18, v47, s58
  v_and_or_b32 v19, v19, v47, s59
  s_mov_b32 exec_lo, 0x3ff03ff
  s_mov_b32 exec_hi, 0x3ff03ff
  buffer_store_dwordx4 v[16:19], v33, s[36:39], s13 offen sc1
  s_mov_b64 exec, -1
  s_cmp_ge_u32 s49, 28
  s_cbranch_scc1 L_fin
  s_cmp_ge_u32 s48, 2
  s_cbranch_scc1 L_tag
  s_lshl_b32 s3, s48, 6
  s_add_u32 s4, s15, s3
  s_add_u32 s4, s4, 524288
  v_lshrrev_b32 v9, 2, v0
  v_and_b32 v13, 3, v0
  v_lshlrev_b32 v9, 7, v9
  v_lshl_add_u32 v9, v13, 4, v9
  s_add_u32 s7, s4, 4096
  s_lshl_b32 s3, s14, 5
  s_lshr_b32 s6, s14, 4
  s_lshl_b32 s6, s6, 2
  s_and_b32 s5, s14, 3
  s_add_u32 s6, s6, s5
  s_lshl_b32 s6, s6, 2
  s_bfe_u32 s5, s14, 0x20002
  s_add_u32 s6, s6, s5
  s_lshl_b32 s6, s6, 5
  s_mul_i32 s5, s48, 1664
  s_add_u32 s6, s6, s5
  s_add_u32 s6, s6, 134656
  v_lshl_add_u32 v12, v13, 2, s6
  ds_read2_b32 v[14:15], v12 offset1:4
  s_mul_i32 s5, s48, 1280
  s_add_u32 s5, s5, s3
  v_lshlrev_b32 v13, 3, v13
  v_lshl_add_u32 v13, v45, 1, v13
  v_cmp_gt_u32 vcc, 4, v0
  s_mov_b32 s44, s22
  s_mov_b32 s45, s23
  s_mov_b32 s46, 2560
  s_mov_b32 s47, 0x20000
  s_waitcnt lgkmcnt(0)
  v_cndmask_b32 v14, 0, v14, vcc
  v_cndmask_b32 v15, 0, v15, vcc
  v_lshlrev_b32 v48, 16, v14
  v_and_b32 v49, 0xffff0000, v14
  v_lshlrev_b32 v50, 16, v15
  v_and_b32 v51, 0xffff0000, v15
  s_waitcnt vmcnt(0)
  buffer_load_dwordx4 v[52:55], v9, s[36:39], s4 offen offset:0 sc1
  buffer_load_dwordx4 v[56:59], v9, s[36:39], s4 offen offset:2048 sc1
  buffer_load_dwordx4 v[60:63], v9, s[36:39], s7 offen offset:0 sc1
  s_mov_b32 s64, 7
  s_mov_b32 s61, 0
  s_mov_b32 s65, 0
  v_mov_b32 v11, 0
  s_waitcnt vmcnt(2)
  v_xor_b32 v52, s56, v52
  v_xor_b32 v53, s57, v53
  v_xor_b32 v54, s58, v54
  v_xor_b32 v55, s59, v55
  v_or3_b32 v10, v52, v53, v54
  v_or_b32 v10, v10, v55
  v_cmp_ne_u32_sdwa vcc, v10, v11 src0_sel:BYTE_0 src1_sel:DWORD
  s_cbranch_vccnz L_dg_f0
  v_pk_add_f32 v[48:49], v[48:49], v[52:53]
  v_pk_add_f32 v[50:51], v[50:51], v[54:55]
  s_bitset0_b32 s64, 0
L_dg_f0:
  s_waitcnt vmcnt(1)
  v_xor_b32 v56, s56, v56
  v_xor_b32 v57, s57, v57
  v_xor_b32 v58, s58, v58
  v_xor_b32 v59, s59, v59
  v_or3_b32 v10, v56, v57, v58
  v_or_b32 v10, v10, v59
  v_cmp_ne_u32_sdwa vcc, v10, v11 src0_sel:BYTE_0 src1_sel:DWORD
  s_cbranch_vccnz L_dg_f1
  v_pk_add_f32 v[48:49], v[48:49], v[56:57]
  v_pk_add_f32 v[50:51], v[50:51], v[58:59]
  s_bitset0_b32 s64, 1
L_dg_f1:
  s_waitcnt vmcnt(0)
  v_xor_b32 v60, s56, v60
  v_xor_b32 v61, s57, v61
  v_xor_b32 v62, s58, v62
  v_xor_b32 v63, s59, v63
  v_or3_b32 v10, v60, v61, v62
  v_or_b32 v10, v10, v63
  v_cmp_ne_u32_sdwa vcc, v10, v11 src0_sel:BYTE_0 src1_sel:DWORD
  s_cbranch_vccnz L_dg_f2
  v_pk_add_f32 v[48:49], v[48:49], v[60:61]
  v_pk_add_f32 v[50:51], v[50:51], v[62:63]
  s_bitset0_b32 s64, 2
L_dg_f2:
  s_cmp_eq_u32 s64, 0
  s_cbranch_scc1 L_dg_done
  s_and_b32 s65, s65, s64
  s_cselect_b32 s65, s65, s64
  s_ff1_i32_b32 s16, s65
  s_bitset0_b32 s65, s16
  s_lshl_b32 s3, s16, 11
  s_add_u32 s3, s3, s4
  buffer_load_dwordx4 v[52:55], v9, s[36:39], s3 offen sc1
  s_and_b32 s65, s65, s64
  s_cselect_b32 s65, s65, s64
  s_ff1_i32_b32 s17, s65
  s_bitset0_b32 s65, s17
  s_lshl_b32 s3, s17, 11
  s_add_u32 s3, s3, s4
  buffer_load_dwordx4 v[56:59], v9, s[36:39], s3 offen sc1
L_dg_rot:
  s_and_b32 s65, s65, s64
  s_cselect_b32 s65, s65, s64
  s_ff1_i32_b32 s18, s65
  s_bitset0_b32 s65, s18
  s_lshl_b32 s3, s18, 11
  s_add_u32 s3, s3, s4
  buffer_load_dwordx4 v[60:63], v9, s[36:39], s3 offen sc1
  s_waitcnt vmcnt(2)
  v_xor_b32 v52, s56, v52
  v_xor_b32 v53, s57, v53
  v_xor_b32 v54, s58, v54
  v_xor_b32 v55, s59, v55
  v_or3_b32 v10, v52, v53, v54
  v_or_b32 v10, v10, v55
  v_cmp_ne_u32_sdwa vcc, v10, v11 src0_sel:BYTE_0 src1_sel:DWORD
  s_cbranch_vccz L_dg_v0
L_dg_b0:
  s_and_b32 s65, s65, s64
  s_cselect_b32 s65, s65, s64
  s_ff1_i32_b32 s16, s65
  s_bitset0_b32 s65, s16
  s_lshl_b32 s3, s16, 11
  s_add_u32 s3, s3, s4
  buffer_load_dwordx4 v[52:55], v9, s[36:39], s3 offen sc1
  s_waitcnt vmcnt(2)
  v_xor_b32 v56, s56, v56
  v_xor_b32 v57, s57, v57
  v_xor_b32 v58, s58, v58
  v_xor_b32 v59, s59, v59
  v_or3_b32 v10, v56, v57, v58
  v_or_b32 v10, v10, v59
  v_cmp_ne_u32_sdwa vcc, v10, v11 src0_sel:BYTE_0 src1_sel:DWORD
  s_cbranch_vccz L_dg_v1
L_dg_b1:
  s_and_b32 s65, s65, s64
  s_cselect_b32 s65, s65, s64
  s_ff1_i32_b32 s17, s65
  s_bitset0_b32 s65, s17
  s_lshl_b32 s3, s17, 11
  s_add_u32 s3, s3, s4
  buffer_load_dwordx4 v[56:59], v9, s[36:39], s3 offen sc1
  s_waitcnt vmcnt(2)
  v_xor_b32 v60, s56, v60
  v_xor_b32 v61, s57, v61
  v_xor_b32 v62, s58, v62
  v_xor_b32 v63, s59, v63
  v_or3_b32 v10, v60, v61, v62
  v_or_b32 v10, v10, v63
  v_cmp_ne_u32_sdwa vcc, v10, v11 src0_sel:BYTE_0 src1_sel:DWORD
  s_cbranch_vccz L_dg_v2
L_dg_b2:
  s_add_u32 s61, s61, 1
  s_cmp_lt_u32 s61, 200000
  s_cbranch_scc1 L_dg_rot
  s_branch L_dg_done
L_dg_v0:
  s_bitcmp1_b32 s64, s16
  s_cbranch_scc0 L_dg_b0
  v_pk_add_f32 v[48:49], v[48:49], v[52:53]
  v_pk_add_f32 v[50:51], v[50:51], v[54:55]
  s_bitset0_b32 s64, s16
  s_cmp_lg_u32 s64, 0
  s_cbranch_scc1 L_dg_b0
  s_branch L_dg_done
L_dg_v1:
  s_bitcmp1_b32 s64, s17
  s_cbranch_scc0 L_dg_b1
  v_pk_add_f32 v[48:49], v[48:49], v[56:57]
  v_pk_add_f32 v[50:51], v[50:51], v[58:59]
  s_bitset0_b32 s64, s17
  s_cmp_lg_u32 s64, 0
  s_cbranch_scc1 L_dg_b1
  s_branch L_dg_done
L_dg_v2:
  s_bitcmp1_b32 s64, s18
  s_cbranch_scc0 L_dg_b2
  v_pk_add_f32 v[48:49], v[48:49], v[60:61]
  v_pk_add_f32 v[50:51], v[50:51], v[62:63]
  s_bitset0_b32 s64, s18
  s_cmp_lg_u32 s64, 0
  s_cbranch_scc1 L_dg_b2
L_dg_done:
  v_permlane32_swap_b32 v48, v50
  v_permlane32_swap_b32 v49, v51
  v_pk_add_f32 v[48:49], v[48:49], v[50:51]
  s_nop 1
  v_permlane16_swap_b32 v48, v49
  v_add_f32 v48, v48, v49
  s_nop 1
  v_add_f32_dpp v48, v48, v48 row_ror:4 row_mask:0xf bank_mask:0xf
  s_nop 1
  v_add_f32_dpp v48, v48, v48 row_ror:8 row_mask:0xf bank_mask:0xf
  v_cvt_pk_bf16_f32 v48, v48, v48
  s_mov_b32 exec_lo, 0xf000f
  s_mov_b32 exec_hi, 0xf000f
  buffer_store_short v48, v13, s[44:47], s5 offen sc0 sc1
L_tag:
  s_xor_b32 s3, s48, 7
  s_or_b32 s3, s54, s3
  s_cbranch_scc1 L_fin
  s_mov_b64 exec, 1
  v_mov_b32 v10, s55
  v_mov_b32 v11, 0
  buffer_store_dword v10, v11, s[36:39], 0 offen sc1
L_fin:
L_end:
  s_endpgm
.section .rodata,"a"
.p2align 6
.amdhsa_kernel sequential_preLN__mha_block_cached__glu_gated_glu__decode_kernel
  .amdhsa_next_free_vgpr 256
  .amdhsa_next_free_sgpr 102
  .amdhsa_accum_offset 256
  .amdhsa_group_segment_fixed_size 0
  .amdhsa_kernarg_size 96
  .amdhsa_user_sgpr_count 2
  .amdhsa_user_sgpr_kernarg_segment_ptr 1
  .amdhsa_system_sgpr_workgroup_id_x 1
  .amdhsa_float_denorm_mode_32 3
.end_amdhsa_kernel
```
